```python
import torch

def _softmax(x, axis=-1):
    return torch.softmax(x, dim=axis)

def _gelu(x):
    return torch.nn.functional.gelu(x, approximate='tanh')

def _silu(x):
    return torch.nn.functional.silu(x)

def _sigmoid(x):
    return torch.sigmoid(x)

def _layernorm(x, axis=-1, eps=1e-05):
    m = x.mean(dim=axis, keepdim=True)
    v = x.var(dim=axis, keepdim=True, unbiased=False)
    return (x - m) / torch.sqrt(v + eps)

def _scatter_add(tgt, idx, src, axis=0):
    return tgt.clone().index_add_(axis, idx, src)

def _segment_sum(src, seg, n):
    out = torch.zeros((n,) + src.shape[1:], dtype=src.dtype)
    return out.index_add_(0, seg, src)

def _pad(x, pw):
    flat = tuple((v for pair in reversed(pw) for v in pair))
    return torch.nn.functional.pad(x, flat)
kernel_name = 'recurrent_scan__ssm_conv_s4d__mixer_gmlp__prompt'

def setup_inputs():

    _w = lambda a: (lambda t: t.to(torch.bfloat16) if t.is_floating_point() else t)(torch.as_tensor(a))

    def _A_setup():
        Bsz, L, D, N = (1, 2048, 512, 128)
        return {'u': _w((lambda *s: torch.randn(*s, dtype=torch.bfloat16) * 0.05)(Bsz, L, D)), 'log_A_real': _w((lambda *s: torch.randn(*s, dtype=torch.bfloat16) * 6.4)(D, N) * 0.5), 'A_imag': _w((lambda *s: torch.randn(*s, dtype=torch.bfloat16) * 0.05)(D, N) * 3.14), 'C_real': _w((lambda *s: torch.randn(*s, dtype=torch.bfloat16) * 0.05)(D, N) / N ** 0.5), 'C_imag': _w((lambda *s: torch.randn(*s, dtype=torch.bfloat16) * 0.05)(D, N) / N ** 0.5), 'log_dt': _w((lambda *s: torch.randn(*s, dtype=torch.bfloat16) * 0.05)(D) * 0.5 - 4.0), 'D_skip': _w((lambda *s: torch.randn(*s, dtype=torch.bfloat16) * 0.05)(D))}
    _A_in = _A_setup()

    def _B_setup():
        B, S, D, F = (1, 2048, 512, 1792)
        Fh = F // 2
        return {'x': _w((lambda *s: torch.randn(*s, dtype=torch.bfloat16) * 0.05)(B, S, D)), 'w_in': _w((lambda *s: torch.randn(*s, dtype=torch.bfloat16) * 0.4)(D, 2 * Fh)), 'w_sp': _w(0.01 * (lambda *s: torch.randn(*s, dtype=torch.bfloat16) * 0.4)(S, S)), 'b_sp': _w(1.0 + 0.01 * (lambda *s: torch.randn(*s, dtype=torch.bfloat16) * 0.05)(S)), 'w_out': _w((lambda *s: torch.randn(*s, dtype=torch.bfloat16) * 0.05)(Fh, D))}
    _B_in = _B_setup()
    return {'A_u': _A_in['u'], 'A_log_A_real': _A_in['log_A_real'], 'A_A_imag': _A_in['A_imag'], 'A_C_real': _A_in['C_real'], 'A_C_imag': _A_in['C_imag'], 'A_log_dt': _A_in['log_dt'], 'A_D_skip': _A_in['D_skip'], 'B_x': _B_in['x'], 'B_w_in': _B_in['w_in'], 'B_w_sp': _B_in['w_sp'], 'B_b_sp': _B_in['b_sp'], 'B_w_out': _B_in['w_out']}

def reference(A_u, A_log_A_real, A_A_imag, A_C_real, A_C_imag, A_log_dt, A_D_skip, B_x, B_w_in, B_w_sp, B_b_sp, B_w_out):

    def _A_ref(u, log_A_real, A_imag, C_real, C_imag, log_dt, D_skip):
        L = u.shape[1]
        dt = torch.exp(log_dt)
        A = -torch.exp(log_A_real) + 1j * A_imag
        C = (C_real + 1j * C_imag) * dt[:, None]
        pos = (lambda x, dt: x.to(dt))(torch.arange(L), log_dt.dtype)
        P = torch.exp((A * dt[:, None])[:, :, None] * pos[None, None, :])
        K = 2.0 * torch.einsum('dn,dnl->dl', C, P).real
        L2 = 2 * L
        u_t = (lambda x, *d: x.permute(*d))(u, 0, 2, 1)
        Kf = (lambda x, *a, **k: torch.fft.rfft(x.float(), *a, **k))(K, L2)
        Uf = (lambda x, *a, **k: torch.fft.rfft(x.float(), *a, **k))(u_t, L2)
        y = (lambda x, *a, **k: torch.fft.irfft(x, *a, **k).to(torch.bfloat16))(Uf * Kf[None, :, :], L2)[:, :, :L]
        y = (lambda x, *d: x.permute(*d))(y, 0, 2, 1)
        return y + u * D_skip[None, None, :]

    def _B_ref(x, w_in, w_sp, b_sp, w_out):
        B, S, D = x.shape
        F = w_in.shape[-1]
        Fh = F // 2
        z = _gelu(torch.einsum('bsd,df->bsf', x, w_in))
        z1 = z[..., :Fh].clone()
        z2 = _layernorm(z[..., Fh:], axis=-1)
        g = torch.einsum('ts,bsf->btf', w_sp, z2) + b_sp[None, :, None]
        return torch.einsum('bsf,fd->bsd', z1 * g, w_out)
    x = A_u
    xn = _layernorm(x, axis=-1)
    s = _A_ref(xn, A_log_A_real, A_A_imag, A_C_real, A_C_imag, A_log_dt, A_D_skip)
    g = _silu(_B_ref(xn, B_w_in, B_w_sp, B_b_sp, B_w_out))
    return x + s * g
```

```asm
; @launch grid=(256,1,1) block=(512,1,1) lds=163840
.amdgcn_target "amdgcn-amd-amdhsa--gfx950"
.text
.globl recurrent_scan__ssm_conv_s4d__mixer_gmlp__prompt_kernel
.p2align 8
.type recurrent_scan__ssm_conv_s4d__mixer_gmlp__prompt_kernel,@function
recurrent_scan__ssm_conv_s4d__mixer_gmlp__prompt_kernel:
    s_cmp_ge_u32 s2, 256
    s_cbranch_scc1 recurrent_scan__ssm_conv_s4d__mixer_gmlp__prompt_kernel_end
    s_load_dwordx2 s[12:13], s[0:1], 0
    s_load_dwordx8 s[36:43], s[0:1], 8
    s_load_dwordx4 s[44:47], s[0:1], 40
    s_getpc_b64 s[62:63]
recurrent_scan__ssm_conv_s4d__mixer_gmlp__prompt_kernel_pc:
    s_lshr_b32 s32, s2, 3
    v_lshrrev_b32_e64 v4, 5, v0
    s_lshl_b32 s32, s32, 11
    v_lshl_add_u32 v4, v4, 7, s32
    v_min_u32 v4, code_end-recurrent_scan__ssm_conv_s4d__mixer_gmlp__prompt_kernel_pc, v4
    v_mov_b32_e64 v5, s63
    v_add_co_u32 v4, vcc, s62, v4
    s_load_dwordx2 s[16:17], s[0:1], 64
    s_load_dwordx2 s[8:9], s[0:1], 112
    v_addc_co_u32 v5, vcc, 0, v5, vcc
    global_load_dword v39, v[4:5], off
    s_load_dwordx2 s[20:21], s[0:1], 72
    s_load_dwordx2 s[24:25], s[0:1], 88
    s_load_dwordx2 s[28:29], s[0:1], 96
    s_load_dwordx2 s[34:35], s[0:1], 80
    v_lshrrev_b32 v1, 6, v0
    v_and_b32 v0, 63, v0
    v_readfirstlane_b32 s60, v1
    s_mov_b32 s14, 2097152
    v_and_b32 v40, 15, v0
    s_mov_b32 s15, 0x20000
    v_lshrrev_b32_e64 v41, 4, v0
    s_mov_b32 s10, 17825792
    s_mov_b32 s11, 0x20000
    v_lshrrev_b32 v42, 3, v0
    s_and_b32 s3, s60, 3
    s_and_b32 s7, s2, 1
    v_and_b32 v43, 7, v0
    s_bfe_u32 s48, s2, 0x20003
    s_lshl2_add_u32 s4, s7, s48
    v_bfe_u32 v44, v0, 2, 2
    s_lshl1_add_u32 s6, s48, s7
    s_lshr_b32 s32, s60, 2
    v_and_b32 v45, 3, v0
    s_xor_b32 s32, s32, s7
    s_lshl1_add_u32 s49, s3, s32
    v_lshlrev_b32 v1, 4, v0
    s_bfe_u32 s7, s2, 0x20001
    s_lshr_b32 s32, s2, 5
    v_xor_b32 v46, v41, v43
    s_lshl3_add_u32 s5, s7, s32
    s_add_u32 s6, s5, s6
    v_lshlrev_b32 v46, 4, v46
    s_and_b32 s6, s6, 7
    s_lshl2_add_u32 s51, s5, s3
    v_xor_b32 v47, 64, v46
    s_lshr_b32 s59, s3, 1
    s_and_b32 s58, s3, 1
    v_mov_b32 v36, 17760256
    s_lshl_b32 s33, s3, 12
    s_cmp_lt_u32 s60, 4
    s_cbranch_scc1 recurrent_scan__ssm_conv_s4d__mixer_gmlp__prompt_kernel_G
    s_mov_b32 s18, 1835008
    s_mov_b32 s19, 0x20000
    s_mov_b32 s26, 917504
    s_mov_b32 s27, 0x20000
    s_lshl_b32 s7, s4, 5
    s_add_u32 s7, s7, s5
    s_lshl1_add_u32 s57, s7, s59
    s_lshl1_add_u32 s7, s57, s58
    s_lshl_b32 s7, s7, 7
    v_lshl_add_u32 v88, v0, 1, s7
    s_lshl_b32 s32, s57, 1
    v_mov_b32 v89, s32
    s_waitcnt lgkmcnt(0)
    v_lshlrev_b32 v97, 7, v0
    v_lshlrev_b32 v107, 8, v0
    s_lshl2_add_u32 s7, s2, s3
    s_lshr_b32 s32, s7, 1
    s_lshl1_add_u32 s7, s32, s7
    s_mul_i32 s7, s7, 896
    s_mov_b64 exec, 0x7f
    buffer_load_dword v109, v97, s[16:19], s7 offen offset:1792
    s_mov_b64 exec, -1
    buffer_load_dword v2, v36, s[8:11], 0 offen
    global_load_ushort v96, v89, s[44:45]
    global_load_ushort v92, v88, s[36:37]
    global_load_ushort v93, v88, s[38:39]
    global_load_ushort v94, v88, s[40:41]
    global_load_ushort v95, v88, s[42:43]
    global_load_ushort v74, v89, s[46:47]
    s_branch recurrent_scan__ssm_conv_s4d__mixer_gmlp__prompt_kernel_H2
recurrent_scan__ssm_conv_s4d__mixer_gmlp__prompt_kernel_G:
    s_lshl_b32 s50, s51, 14
    v_lshl_add_u32 v12, v42, 10, v46
    v_lshl_add_u32 v13, v42, 10, v47
    v_add_u32 v13, 7168, v13
    s_lshl_b32 s32, s51, 5
    v_lshl_add_u32 v8, v40, 1, s32
    s_add_u32 s7, s6, 0
    s_and_b32 s7, s7, 7
    s_lshl_b32 s7, s7, 7
    s_add_u32 m0, s33, 98304
    s_add_u32 s7, s7, s50
    s_waitcnt lgkmcnt(0)
    buffer_load_dwordx4 v12, s[12:15], s7 offen offset:0 lds
    buffer_load_dwordx4 v13, s[12:15], s7 offen offset:1024 lds
    s_add_u32 s7, s6, 1
    s_and_b32 s7, s7, 7
    s_lshl_b32 s7, s7, 7
    s_add_u32 m0, s33, 100352
    s_add_u32 s7, s7, s50
    buffer_load_dwordx4 v12, s[12:15], s7 offen offset:0 lds
    buffer_load_dwordx4 v13, s[12:15], s7 offen offset:1024 lds
    buffer_load_dword v2, v36, s[8:11], 0 offen
    global_load_ushort v8, v8, s[34:35]
    s_sub_u32 s20, s20, 4096
    s_subb_u32 s21, s21, 0
    s_mov_b32 s22, 8392704
    s_mov_b32 s23, 0x20000
    s_mov_b32 s30, 2097152
    s_mov_b32 s31, 0x20000
    v_lshrrev_b32 v48, 1, v40
    v_xor_b32 v48, v48, v41
    v_lshlrev_b32 v48, 4, v48
    v_lshl_add_u32 v48, v40, 7, v48
    s_lshl_b32 s7, s3, 13
    s_add_u32 s62, s7, 49152
    v_add_u32 v124, s62, v48
    v_xor_b32 v125, 64, v124
    s_add_u32 s63, s7, 81920
    v_add_u32 v126, s63, v48
    v_xor_b32 v127, 64, v126
    s_lshl_b32 s7, s5, 18
    s_lshl_b32 s32, s49, 9
    s_add_u32 s7, s7, s32
    v_lshlrev_b32 v35, 7, v43
    s_lshl_b32 s32, s59, 17
    s_add_u32 s64, s7, s32
    s_and_b32 s7, s48, 1
    s_lshl_b32 s65, s7, 8
    v_lshl_add_u32 v120, v42, 12, v46
    s_xor_b32 s7, s58, 0
    s_lshl_b32 s7, s7, 16
    s_add_u32 s7, s7, 4096
    v_add_u32 v120, s7, v120
    v_lshl_add_u32 v121, v42, 12, v47
    s_xor_b32 s7, s58, 0
    s_lshl_b32 s7, s7, 16
    s_add_u32 s7, s7, 35840
    v_add_u32 v121, s7, v121
    v_lshl_add_u32 v122, v42, 12, v46
    s_xor_b32 s7, s58, 1
    s_lshl_b32 s7, s7, 16
    s_add_u32 s7, s7, 2048
    v_add_u32 v122, s7, v122
    v_lshl_add_u32 v123, v42, 12, v47
    s_xor_b32 s7, s58, 1
    s_lshl_b32 s7, s7, 16
    s_add_u32 s7, s7, 33792
    v_add_u32 v123, s7, v123
    s_and_b32 s35, s48, 0
    s_lshl_b32 s35, s35, 7
    s_xor_b32 s7, s35, 0
    v_lshl_add_u32 v26, s7, 4, v1
    s_xor_b32 s7, s35, 128
    v_lshl_add_u32 v27, s7, 4, v1
    s_xor_b32 s7, s35, 256
    v_lshl_add_u32 v28, s7, 4, v1
    s_xor_b32 s7, s35, 384
    v_lshl_add_u32 v29, s7, 4, v1
    s_xor_b32 s7, s3, 0
    s_mul_i32 s7, s7, 7168
    s_add_u32 s7, s7, 49152
    v_add_u32 v33, s7, v1
    s_xor_b32 s7, s3, 1
    s_mul_i32 s7, s7, 7168
    s_add_u32 s7, s7, 49152
    v_add_u32_e64 v30, s7, v1
    s_xor_b32 s7, s3, 2
    s_mul_i32 s7, s7, 7168
    s_add_u32 s7, s7, 50176
    v_add_u32 v31, s7, v1
    s_xor_b32 s7, s3, 3
    s_mul_i32 s7, s7, 7168
    s_add_u32 s7, s7, 51200
    v_add_u32 v32, s7, v1
    s_add_u32 s7, s33, 98304
    v_add_u32 v14, s7, v48
    v_xor_b32_e64 v15, 64, v14
    s_add_u32 s7, s33, 147456
    v_lshl_add_u32 v48, v40, 7, v46
    v_add_u32 v18, s7, v48
    v_and_b32 v46, 1, v41
    v_lshrrev_b32 v47, 5, v0
    v_lshl_add_u32 v48, v46, 2, v44
    v_lshl_add_u32 v48, v47, 4, v48
    v_mul_u32_u24 v48, 224, v48
    v_lshl_add_u32 v16, v45, 3, v48
    v_add_u32 v17, 57344, v16
    v_lshlrev_b32 v48, 4, v40
    v_lshl_add_u32 v19, v41, 28, v48
    v_lshl_add_u32 v20, v41, 9, v48
    v_mul_u32_u24 v49, 232, v40
    v_lshl_add_u32 v49, v41, 3, v49
    v_add_u32_e64 v21, s62, v49
    v_lshl_add_u32 v49, v46, 3, v44
    v_mul_u32_u24 v49, 232, v49
    v_lshl_add_u32 v49, v47, 5, v49
    v_lshl_add_u32 v49, v45, 3, v49
    v_add_u32 v22, s62, v49
    v_lshl_add_u32 v48, v46, 8, v48
    v_mul_u32_u24 v49, 66560, v47
    v_add_u32 v23, v48, v49
    v_lshlrev_b32_e64 v34, 25, v0
    s_mov_b32 s52, 0x3f803f80
    s_mov_b32 s53, 0xffff0000
    s_mov_b32 s38, 0xc0135761
    s_mov_b32 s39, 0xbdd2d3e8
    s_lshl_b32 s36, s51, 11
    s_add_u32 s36, s36, 16777216
    s_xor_b32 s32, s4, 1
    s_lshl_b32 s7, s32, 8
    s_add_u32 s37, s36, s7
    s_mul_i32 s56, s32, 465920
    s_lshl_b32 s7, s51, 9
    s_add_u32 s56, s56, s7
    v_mov_b32 v192, s52
    v_mov_b32 v193, s52
    v_mov_b32 v194, s52
    v_mov_b32 v195, s52
    s_mov_b32 s40, 0x100001
    s_mov_b32 s41, 0x10000100
    s_mov_b32 s42, 0x200002
    s_mov_b32 s43, 0x20000200
    s_mov_b32 s44, 0x400004
    s_mov_b32 s45, 0x40000400
    s_mov_b32 s46, 0x800008
    s_mov_b32 s47, 0x80000800
    s_add_u32 s7, s6, 2
    s_and_b32 s7, s7, 7
    s_lshl_b32 s7, s7, 7
    s_add_u32 m0, s33, 114688
    s_add_u32 s7, s7, s50
    buffer_load_dwordx4 v12, s[12:15], s7 offen offset:0 lds
    buffer_load_dwordx4 v13, s[12:15], s7 offen offset:1024 lds
    s_add_u32 s7, s6, 3
    s_and_b32 s7, s7, 7
    s_lshl_b32 s7, s7, 7
    s_add_u32 m0, s33, 116736
    s_add_u32 s7, s7, s50
    buffer_load_dwordx4 v12, s[12:15], s7 offen offset:0 lds
    buffer_load_dwordx4 v13, s[12:15], s7 offen offset:1024 lds
    s_add_u32 s7, s6, 4
    s_and_b32 s7, s7, 7
    s_lshl_b32 s7, s7, 7
    s_add_u32 m0, s33, 131072
    s_add_u32 s7, s7, s50
    buffer_load_dwordx4 v12, s[12:15], s7 offen offset:0 lds
    buffer_load_dwordx4 v13, s[12:15], s7 offen offset:1024 lds
    s_add_u32 s7, s6, 5
    s_and_b32 s7, s7, 7
    s_lshl_b32 s7, s7, 7
    s_add_u32 m0, s33, 133120
    s_add_u32 s7, s7, s50
    buffer_load_dwordx4 v12, s[12:15], s7 offen offset:0 lds
    buffer_load_dwordx4 v13, s[12:15], s7 offen offset:1024 lds
    s_add_u32 s7, s6, 6
    s_and_b32 s7, s7, 7
    s_lshl_b32 s7, s7, 7
    s_add_u32 m0, s33, 147456
    s_add_u32 s7, s7, s50
    buffer_load_dwordx4 v12, s[12:15], s7 offen offset:0 lds
    buffer_load_dwordx4 v13, s[12:15], s7 offen offset:1024 lds
    s_add_u32 s7, s6, 7
    s_and_b32 s7, s7, 7
    s_lshl_b32 s7, s7, 7
    s_add_u32 m0, s33, 149504
    s_add_u32 s7, s7, s50
    buffer_load_dwordx4 v12, s[12:15], s7 offen offset:0 lds
    buffer_load_dwordx4 v13, s[12:15], s7 offen offset:1024 lds
    s_setprio 2
    s_waitcnt vmcnt(16)
    ds_read_b128 v[56:59], v14 offset:0
    ds_read_b128 v[60:63], v15 offset:0
    s_waitcnt vmcnt(14)
    ds_read_b128 v[64:67], v14 offset:2048
    ds_read_b128 v[68:71], v15 offset:2048
    s_waitcnt vmcnt(13)
    v_add_u32 v2, 1, v2
    v_xor_b32 v3, 0x9e3779b9, v2
    s_waitcnt vmcnt(12)
    v_lshlrev_b32 v4, 16, v8
    v_lshlrev_b32 v5, 16, v8
    v_lshlrev_b32 v6, 16, v8
    v_lshlrev_b32 v7, 16, v8
    s_waitcnt vmcnt(10)
    ds_read_b128 v[72:75], v14 offset:16384
    ds_read_b128 v[76:79], v15 offset:16384
    s_waitcnt lgkmcnt(5)
    v_mfma_f32_16x16x32_bf16 v[204:207], v[56:59], v[56:59], 0
    v_mfma_f32_16x16x32_bf16 v[200:203], v[192:195], v[56:59], 0
    s_waitcnt lgkmcnt(4)
    v_mfma_f32_16x16x32_bf16 v[204:207], v[60:63], v[60:63], v[204:207]
    v_mfma_f32_16x16x32_bf16 v[200:203], v[192:195], v[60:63], v[200:203]
    s_waitcnt vmcnt(8)
    ds_read_b128 v[80:83], v14 offset:18432
    ds_read_b128 v[84:87], v15 offset:18432
    s_waitcnt lgkmcnt(5)
    v_mfma_f32_16x16x32_bf16 v[204:207], v[64:67], v[64:67], v[204:207]
    v_lshlrev_b32 v128, 16, v56
    v_and_b32 v56, s53, v56
    v_lshlrev_b32 v129, 16, v57
    v_and_b32 v57, s53, v57
    v_mfma_f32_16x16x32_bf16 v[200:203], v[192:195], v[64:67], v[200:203]
    v_lshlrev_b32 v130, 16, v58
    v_and_b32 v58, s53, v58
    v_lshlrev_b32 v131, 16, v59
    v_and_b32 v59, s53, v59
    s_waitcnt lgkmcnt(4)
    v_mfma_f32_16x16x32_bf16 v[204:207], v[68:71], v[68:71], v[204:207]
    v_lshlrev_b32 v132, 16, v60
    v_and_b32 v60, s53, v60
    v_lshlrev_b32 v133, 16, v61
    v_and_b32 v61, s53, v61
    v_mfma_f32_16x16x32_bf16 v[200:203], v[192:195], v[68:71], v[200:203]
    v_lshlrev_b32 v134, 16, v62
    v_and_b32 v62, s53, v62
    v_lshlrev_b32 v135, 16, v63
    v_and_b32_e64 v63, s53, v63
    s_waitcnt vmcnt(6)
    ds_read_b128 v[88:91], v14 offset:32768
    ds_read_b128 v[92:95], v15 offset:32768
    s_waitcnt lgkmcnt(5)
    v_mfma_f32_16x16x32_bf16 v[204:207], v[72:75], v[72:75], v[204:207]
    v_lshlrev_b32 v136, 16, v64
    v_and_b32 v64, s53, v64
    v_lshlrev_b32 v137, 16, v65
    v_and_b32 v65, s53, v65
    v_mfma_f32_16x16x32_bf16 v[200:203], v[192:195], v[72:75], v[200:203]
    v_lshlrev_b32 v138, 16, v66
    v_and_b32 v66, s53, v66
    v_lshlrev_b32 v139, 16, v67
    v_and_b32 v67, s53, v67
    s_waitcnt lgkmcnt(4)
    v_mfma_f32_16x16x32_bf16 v[204:207], v[76:79], v[76:79], v[204:207]
    v_lshlrev_b32 v140, 16, v68
    v_and_b32 v68, s53, v68
    v_lshlrev_b32 v141, 16, v69
    v_and_b32 v69, s53, v69
    v_mfma_f32_16x16x32_bf16 v[200:203], v[192:195], v[76:79], v[200:203]
    v_lshlrev_b32 v142, 16, v70
    v_and_b32 v70, s53, v70
    v_lshlrev_b32 v143, 16, v71
    v_and_b32_e64 v71, s53, v71
    s_waitcnt vmcnt(4)
    ds_read_b128 v[96:99], v14 offset:34816
    ds_read_b128 v[100:103], v15 offset:34816
    s_waitcnt lgkmcnt(5)
    v_mfma_f32_16x16x32_bf16 v[204:207], v[80:83], v[80:83], v[204:207]
    v_lshlrev_b32 v144, 16, v72
    v_and_b32 v72, s53, v72
    v_lshlrev_b32 v145, 16, v73
    v_and_b32 v73, s53, v73
    v_mfma_f32_16x16x32_bf16 v[200:203], v[192:195], v[80:83], v[200:203]
    v_lshlrev_b32 v146, 16, v74
    v_and_b32 v74, s53, v74
    v_lshlrev_b32 v147, 16, v75
    v_and_b32 v75, s53, v75
    s_waitcnt lgkmcnt(4)
    v_mfma_f32_16x16x32_bf16 v[204:207], v[84:87], v[84:87], v[204:207]
    v_lshlrev_b32 v148, 16, v76
    v_and_b32 v76, s53, v76
    v_lshlrev_b32 v149, 16, v77
    v_and_b32 v77, s53, v77
    v_mfma_f32_16x16x32_bf16 v[200:203], v[192:195], v[84:87], v[200:203]
    v_lshlrev_b32 v150, 16, v78
    v_and_b32 v78, s53, v78
    v_lshlrev_b32 v151, 16, v79
    v_and_b32_e64 v79, s53, v79
    s_waitcnt vmcnt(2)
    ds_read_b128 v[104:107], v14 offset:49152
    ds_read_b128 v[108:111], v15 offset:49152
    s_waitcnt lgkmcnt(5)
    v_mfma_f32_16x16x32_bf16 v[204:207], v[88:91], v[88:91], v[204:207]
    v_lshlrev_b32 v152, 16, v80
    v_and_b32 v80, s53, v80
    v_lshlrev_b32 v153, 16, v81
    v_and_b32 v81, s53, v81
    v_mfma_f32_16x16x32_bf16 v[200:203], v[192:195], v[88:91], v[200:203]
    v_lshlrev_b32 v154, 16, v82
    v_and_b32 v82, s53, v82
    v_lshlrev_b32 v155, 16, v83
    v_and_b32 v83, s53, v83
    s_waitcnt lgkmcnt(4)
    v_mfma_f32_16x16x32_bf16 v[204:207], v[92:95], v[92:95], v[204:207]
    v_lshlrev_b32 v156, 16, v84
    v_and_b32 v84, s53, v84
    v_lshlrev_b32 v157, 16, v85
    v_and_b32 v85, s53, v85
    v_mfma_f32_16x16x32_bf16 v[200:203], v[192:195], v[92:95], v[200:203]
    v_lshlrev_b32 v158, 16, v86
    v_and_b32 v86, s53, v86
    v_lshlrev_b32 v159, 16, v87
    v_and_b32_e64 v87, s53, v87
    s_waitcnt vmcnt(0)
    ds_read_b128 v[112:115], v14 offset:51200
    ds_read_b128 v[116:119], v15 offset:51200
    s_waitcnt lgkmcnt(5)
    v_mfma_f32_16x16x32_bf16 v[204:207], v[96:99], v[96:99], v[204:207]
    v_lshlrev_b32 v160, 16, v88
    v_and_b32 v88, s53, v88
    v_lshlrev_b32 v161, 16, v89
    v_and_b32 v89, s53, v89
    v_mfma_f32_16x16x32_bf16 v[200:203], v[192:195], v[96:99], v[200:203]
    v_lshlrev_b32 v162, 16, v90
    v_and_b32 v90, s53, v90
    v_lshlrev_b32 v163, 16, v91
    v_and_b32 v91, s53, v91
    s_waitcnt lgkmcnt(4)
    v_mfma_f32_16x16x32_bf16 v[204:207], v[100:103], v[100:103], v[204:207]
    v_lshlrev_b32 v164, 16, v92
    v_and_b32 v92, s53, v92
    v_lshlrev_b32 v165, 16, v93
    v_and_b32 v93, s53, v93
    v_mfma_f32_16x16x32_bf16 v[200:203], v[192:195], v[100:103], v[200:203]
    v_lshlrev_b32 v166, 16, v94
    v_and_b32 v94, s53, v94
    v_lshlrev_b32 v167, 16, v95
    v_and_b32_e64 v95, s53, v95
    s_waitcnt lgkmcnt(3)
    v_mfma_f32_16x16x32_bf16 v[204:207], v[104:107], v[104:107], v[204:207]
    v_lshlrev_b32 v168, 16, v96
    v_and_b32 v96, s53, v96
    v_lshlrev_b32 v169, 16, v97
    v_and_b32 v97, s53, v97
    v_mfma_f32_16x16x32_bf16 v[200:203], v[192:195], v[104:107], v[200:203]
    v_lshlrev_b32 v170, 16, v98
    v_and_b32 v98, s53, v98
    v_lshlrev_b32 v171, 16, v99
    v_and_b32 v99, s53, v99
    s_waitcnt lgkmcnt(2)
    v_mfma_f32_16x16x32_bf16 v[204:207], v[108:111], v[108:111], v[204:207]
    v_lshlrev_b32 v172, 16, v100
    v_and_b32 v100, s53, v100
    v_lshlrev_b32 v173, 16, v101
    v_and_b32 v101, s53, v101
    v_mfma_f32_16x16x32_bf16 v[200:203], v[192:195], v[108:111], v[200:203]
    v_lshlrev_b32 v174, 16, v102
    v_and_b32 v102, s53, v102
    v_lshlrev_b32 v175, 16, v103
    v_and_b32 v103, s53, v103
    s_waitcnt lgkmcnt(1)
    v_mfma_f32_16x16x32_bf16 v[204:207], v[112:115], v[112:115], v[204:207]
    v_lshlrev_b32 v176, 16, v104
    v_and_b32 v104, s53, v104
    v_lshlrev_b32 v177, 16, v105
    v_and_b32 v105, s53, v105
    v_mfma_f32_16x16x32_bf16 v[200:203], v[192:195], v[112:115], v[200:203]
    v_lshlrev_b32 v178, 16, v106
    v_and_b32 v106, s53, v106
    v_lshlrev_b32 v179, 16, v107
    v_and_b32 v107, s53, v107
    s_waitcnt lgkmcnt(0)
    v_mfma_f32_16x16x32_bf16 v[204:207], v[116:119], v[116:119], v[204:207]
    v_lshlrev_b32 v180, 16, v108
    v_and_b32 v108, s53, v108
    v_lshlrev_b32 v181, 16, v109
    v_and_b32 v109, s53, v109
    v_mfma_f32_16x16x32_bf16 v[200:203], v[192:195], v[116:119], v[200:203]
    v_lshlrev_b32 v182, 16, v110
    v_and_b32 v110, s53, v110
    v_lshlrev_b32 v183, 16, v111
    v_and_b32 v111, s53, v111
    s_sub_u32 s7, s4, s6
    s_and_b32 s32, s7, 1
    s_bfe_u32 s7, s7, 0x20001
    s_lshl3_add_u32 s7, s7, s32
    s_lshl_b32 s7, s7, 11
    s_add_u32 s7, s7, s33
    s_add_u32 s7, s7, 98304
    v_add_u32_e64 v12, s7, v1
    ds_read_b128 v[8:11], v12
    ds_read_b64 v[24:25], v12 offset:1024
    ds_read_b64 v[38:39], v12 offset:1032
    v_lshlrev_b32 v184, 16, v112
    v_and_b32 v112, s53, v112
    v_lshlrev_b32 v185, 16, v113
    v_and_b32 v113, s53, v113
    v_cndmask_b32 v49, 0, v204, s[40:41]
    v_lshlrev_b32 v186, 16, v114
    v_cndmask_b32 v49, v49, v205, s[42:43]
    v_cndmask_b32 v49, v49, v206, s[44:45]
    v_and_b32 v114, s53, v114
    v_cndmask_b32 v49, v49, v207, s[46:47]
    v_mov_b32 v48, v200
    v_lshlrev_b32 v187, 16, v115
    v_mov_b32 v50, v49
    s_nop 1
    v_permlane32_swap_b32 v49, v50
    v_add_f32 v49, v49, v50
    v_and_b32 v115, s53, v115
    v_mov_b32 v50, v49
    s_nop 1
    v_permlane16_swap_b32 v49, v50
    v_lshlrev_b32 v188, 16, v116
    v_add_f32 v49, v49, v50
    v_mul_f32 v48, 0x3b000000, v48
    v_and_b32 v116, s53, v116
    v_mul_f32 v50, v48, v48
    v_mul_f32 v49, 0x3b000000, v49
    v_sub_f32 v49, v49, v50
    v_lshlrev_b32 v189, 16, v117
    v_max_f32 v49, 0, v49
    v_cvt_pk_bf16_f32 v49, v49, v49
    v_and_b32 v117, s53, v117
    v_and_b32 v49, 0xffff0000, v49
    v_cvt_pk_bf16_f32 v48, v48, v48
    v_lshlrev_b32_e64 v190, 16, v118
    v_and_b32 v48, 0xffff0000, v48
    v_add_f32 v49, 0x3727c5ac, v49
    v_cvt_pk_bf16_f32 v49, v49, v49
    v_and_b32 v118, s53, v118
    v_and_b32 v49, 0xffff0000, v49
    v_sqrt_f32 v49, v49
    v_lshlrev_b32 v191, 16, v119
    v_cvt_pk_bf16_f32 v49, v49, v49
    v_and_b32 v49, 0xffff0000, v49
    v_and_b32 v119, s53, v119
    v_rcp_f32 v49, v49
    s_nop 0
    v_mul_f32 v48, -v48, v49
    v_pk_fma_f32 v[128:129], v[128:129], v[48:49], v[48:49] op_sel:[0,1,0] op_sel_hi:[1,1,0]
    v_pk_fma_f32 v[56:57], v[56:57], v[48:49], v[48:49] op_sel:[0,1,0] op_sel_hi:[1,1,0]
    v_pk_fma_f32 v[130:131], v[130:131], v[48:49], v[48:49] op_sel:[0,1,0] op_sel_hi:[1,1,0]
    v_pk_fma_f32 v[58:59], v[58:59], v[48:49], v[48:49] op_sel:[0,1,0] op_sel_hi:[1,1,0]
    v_cvt_pk_bf16_f32 v56, v128, v56
    v_cvt_pk_bf16_f32 v57, v129, v57
    v_cvt_pk_bf16_f32 v58, v130, v58
    v_cvt_pk_bf16_f32 v59, v131, v59
    ds_write_b128 v18, v[56:59]
    v_xor_b32_e64 v18, 64, v18
    v_pk_fma_f32 v[132:133], v[132:133], v[48:49], v[48:49] op_sel:[0,1,0] op_sel_hi:[1,1,0]
    v_pk_fma_f32 v[60:61], v[60:61], v[48:49], v[48:49] op_sel:[0,1,0] op_sel_hi:[1,1,0]
    v_pk_fma_f32 v[134:135], v[134:135], v[48:49], v[48:49] op_sel:[0,1,0] op_sel_hi:[1,1,0]
    v_pk_fma_f32 v[62:63], v[62:63], v[48:49], v[48:49] op_sel:[0,1,0] op_sel_hi:[1,1,0]
    v_cvt_pk_bf16_f32 v60, v132, v60
    v_cvt_pk_bf16_f32 v61, v133, v61
    v_cvt_pk_bf16_f32 v62, v134, v62
    v_cvt_pk_bf16_f32 v63, v135, v63
    ds_write_b128 v18, v[60:63]
    v_pk_fma_f32 v[136:137], v[136:137], v[48:49], v[48:49] op_sel:[0,1,0] op_sel_hi:[1,1,0]
    v_pk_fma_f32 v[64:65], v[64:65], v[48:49], v[48:49] op_sel:[0,1,0] op_sel_hi:[1,1,0]
    v_pk_fma_f32 v[138:139], v[138:139], v[48:49], v[48:49] op_sel:[0,1,0] op_sel_hi:[1,1,0]
    v_pk_fma_f32 v[66:67], v[66:67], v[48:49], v[48:49] op_sel:[0,1,0] op_sel_hi:[1,1,0]
    v_cvt_pk_bf16_f32 v64, v136, v64
    v_cvt_pk_bf16_f32 v65, v137, v65
    v_cvt_pk_bf16_f32 v66, v138, v66
    v_cvt_pk_bf16_f32 v67, v139, v67
    v_pk_fma_f32 v[140:141], v[140:141], v[48:49], v[48:49] op_sel:[0,1,0] op_sel_hi:[1,1,0]
    v_pk_fma_f32 v[68:69], v[68:69], v[48:49], v[48:49] op_sel:[0,1,0] op_sel_hi:[1,1,0]
    v_pk_fma_f32 v[142:143], v[142:143], v[48:49], v[48:49] op_sel:[0,1,0] op_sel_hi:[1,1,0]
    v_pk_fma_f32 v[70:71], v[70:71], v[48:49], v[48:49] op_sel:[0,1,0] op_sel_hi:[1,1,0]
    v_cvt_pk_bf16_f32 v68, v140, v68
    v_cvt_pk_bf16_f32 v69, v141, v69
    v_cvt_pk_bf16_f32 v70, v142, v70
    v_cvt_pk_bf16_f32 v71, v143, v71
    v_pk_fma_f32 v[144:145], v[144:145], v[48:49], v[48:49] op_sel:[0,1,0] op_sel_hi:[1,1,0]
    v_pk_fma_f32 v[72:73], v[72:73], v[48:49], v[48:49] op_sel:[0,1,0] op_sel_hi:[1,1,0]
    v_pk_fma_f32 v[146:147], v[146:147], v[48:49], v[48:49] op_sel:[0,1,0] op_sel_hi:[1,1,0]
    v_pk_fma_f32 v[74:75], v[74:75], v[48:49], v[48:49] op_sel:[0,1,0] op_sel_hi:[1,1,0]
    v_cvt_pk_bf16_f32 v72, v144, v72
    v_cvt_pk_bf16_f32 v73, v145, v73
    v_cvt_pk_bf16_f32 v74, v146, v74
    v_cvt_pk_bf16_f32 v75, v147, v75
    v_pk_fma_f32 v[148:149], v[148:149], v[48:49], v[48:49] op_sel:[0,1,0] op_sel_hi:[1,1,0]
    v_pk_fma_f32 v[76:77], v[76:77], v[48:49], v[48:49] op_sel:[0,1,0] op_sel_hi:[1,1,0]
    v_pk_fma_f32 v[150:151], v[150:151], v[48:49], v[48:49] op_sel:[0,1,0] op_sel_hi:[1,1,0]
    v_pk_fma_f32 v[78:79], v[78:79], v[48:49], v[48:49] op_sel:[0,1,0] op_sel_hi:[1,1,0]
    v_cvt_pk_bf16_f32 v76, v148, v76
    v_cvt_pk_bf16_f32 v77, v149, v77
    v_cvt_pk_bf16_f32 v78, v150, v78
    v_cvt_pk_bf16_f32 v79, v151, v79
    v_pk_fma_f32 v[152:153], v[152:153], v[48:49], v[48:49] op_sel:[0,1,0] op_sel_hi:[1,1,0]
    v_pk_fma_f32 v[80:81], v[80:81], v[48:49], v[48:49] op_sel:[0,1,0] op_sel_hi:[1,1,0]
    v_pk_fma_f32 v[154:155], v[154:155], v[48:49], v[48:49] op_sel:[0,1,0] op_sel_hi:[1,1,0]
    v_pk_fma_f32 v[82:83], v[82:83], v[48:49], v[48:49] op_sel:[0,1,0] op_sel_hi:[1,1,0]
    v_cvt_pk_bf16_f32 v80, v152, v80
    v_cvt_pk_bf16_f32 v81, v153, v81
    v_cvt_pk_bf16_f32 v82, v154, v82
    v_cvt_pk_bf16_f32 v83, v155, v83
    v_pk_fma_f32 v[156:157], v[156:157], v[48:49], v[48:49] op_sel:[0,1,0] op_sel_hi:[1,1,0]
    v_pk_fma_f32 v[84:85], v[84:85], v[48:49], v[48:49] op_sel:[0,1,0] op_sel_hi:[1,1,0]
    v_pk_fma_f32 v[158:159], v[158:159], v[48:49], v[48:49] op_sel:[0,1,0] op_sel_hi:[1,1,0]
    v_pk_fma_f32 v[86:87], v[86:87], v[48:49], v[48:49] op_sel:[0,1,0] op_sel_hi:[1,1,0]
    v_cvt_pk_bf16_f32 v84, v156, v84
    v_cvt_pk_bf16_f32 v85, v157, v85
    v_cvt_pk_bf16_f32 v86, v158, v86
    v_cvt_pk_bf16_f32 v87, v159, v87
    v_pk_fma_f32 v[160:161], v[160:161], v[48:49], v[48:49] op_sel:[0,1,0] op_sel_hi:[1,1,0]
    v_pk_fma_f32 v[88:89], v[88:89], v[48:49], v[48:49] op_sel:[0,1,0] op_sel_hi:[1,1,0]
    v_pk_fma_f32 v[162:163], v[162:163], v[48:49], v[48:49] op_sel:[0,1,0] op_sel_hi:[1,1,0]
    v_pk_fma_f32 v[90:91], v[90:91], v[48:49], v[48:49] op_sel:[0,1,0] op_sel_hi:[1,1,0]
    v_cvt_pk_bf16_f32 v88, v160, v88
    v_cvt_pk_bf16_f32 v89, v161, v89
    v_cvt_pk_bf16_f32 v90, v162, v90
    v_cvt_pk_bf16_f32 v91, v163, v91
    v_pk_fma_f32 v[164:165], v[164:165], v[48:49], v[48:49] op_sel:[0,1,0] op_sel_hi:[1,1,0]
    v_pk_fma_f32 v[92:93], v[92:93], v[48:49], v[48:49] op_sel:[0,1,0] op_sel_hi:[1,1,0]
    v_pk_fma_f32 v[166:167], v[166:167], v[48:49], v[48:49] op_sel:[0,1,0] op_sel_hi:[1,1,0]
    v_pk_fma_f32 v[94:95], v[94:95], v[48:49], v[48:49] op_sel:[0,1,0] op_sel_hi:[1,1,0]
    v_cvt_pk_bf16_f32 v92, v164, v92
    v_cvt_pk_bf16_f32 v93, v165, v93
    v_cvt_pk_bf16_f32 v94, v166, v94
    v_cvt_pk_bf16_f32 v95, v167, v95
    v_pk_fma_f32 v[168:169], v[168:169], v[48:49], v[48:49] op_sel:[0,1,0] op_sel_hi:[1,1,0]
    v_pk_fma_f32 v[96:97], v[96:97], v[48:49], v[48:49] op_sel:[0,1,0] op_sel_hi:[1,1,0]
    v_pk_fma_f32 v[170:171], v[170:171], v[48:49], v[48:49] op_sel:[0,1,0] op_sel_hi:[1,1,0]
    v_pk_fma_f32 v[98:99], v[98:99], v[48:49], v[48:49] op_sel:[0,1,0] op_sel_hi:[1,1,0]
    v_cvt_pk_bf16_f32 v96, v168, v96
    v_cvt_pk_bf16_f32 v97, v169, v97
    v_cvt_pk_bf16_f32 v98, v170, v98
    v_cvt_pk_bf16_f32 v99, v171, v99
    v_pk_fma_f32 v[172:173], v[172:173], v[48:49], v[48:49] op_sel:[0,1,0] op_sel_hi:[1,1,0]
    v_pk_fma_f32 v[100:101], v[100:101], v[48:49], v[48:49] op_sel:[0,1,0] op_sel_hi:[1,1,0]
    v_pk_fma_f32 v[174:175], v[174:175], v[48:49], v[48:49] op_sel:[0,1,0] op_sel_hi:[1,1,0]
    v_pk_fma_f32 v[102:103], v[102:103], v[48:49], v[48:49] op_sel:[0,1,0] op_sel_hi:[1,1,0]
    v_cvt_pk_bf16_f32 v100, v172, v100
    v_cvt_pk_bf16_f32 v101, v173, v101
    v_cvt_pk_bf16_f32 v102, v174, v102
    v_cvt_pk_bf16_f32 v103, v175, v103
    v_pk_fma_f32 v[176:177], v[176:177], v[48:49], v[48:49] op_sel:[0,1,0] op_sel_hi:[1,1,0]
    v_pk_fma_f32 v[104:105], v[104:105], v[48:49], v[48:49] op_sel:[0,1,0] op_sel_hi:[1,1,0]
    v_pk_fma_f32 v[178:179], v[178:179], v[48:49], v[48:49] op_sel:[0,1,0] op_sel_hi:[1,1,0]
    v_pk_fma_f32 v[106:107], v[106:107], v[48:49], v[48:49] op_sel:[0,1,0] op_sel_hi:[1,1,0]
    v_cvt_pk_bf16_f32 v104, v176, v104
    v_cvt_pk_bf16_f32 v105, v177, v105
    v_cvt_pk_bf16_f32 v106, v178, v106
    v_cvt_pk_bf16_f32 v107, v179, v107
    v_pk_fma_f32 v[180:181], v[180:181], v[48:49], v[48:49] op_sel:[0,1,0] op_sel_hi:[1,1,0]
    v_pk_fma_f32 v[108:109], v[108:109], v[48:49], v[48:49] op_sel:[0,1,0] op_sel_hi:[1,1,0]
    v_pk_fma_f32 v[182:183], v[182:183], v[48:49], v[48:49] op_sel:[0,1,0] op_sel_hi:[1,1,0]
    v_pk_fma_f32 v[110:111], v[110:111], v[48:49], v[48:49] op_sel:[0,1,0] op_sel_hi:[1,1,0]
    v_cvt_pk_bf16_f32 v108, v180, v108
    v_cvt_pk_bf16_f32 v109, v181, v109
    v_cvt_pk_bf16_f32 v110, v182, v110
    v_cvt_pk_bf16_f32 v111, v183, v111
    v_pk_fma_f32 v[184:185], v[184:185], v[48:49], v[48:49] op_sel:[0,1,0] op_sel_hi:[1,1,0]
    v_pk_fma_f32 v[112:113], v[112:113], v[48:49], v[48:49] op_sel:[0,1,0] op_sel_hi:[1,1,0]
    v_pk_fma_f32 v[186:187], v[186:187], v[48:49], v[48:49] op_sel:[0,1,0] op_sel_hi:[1,1,0]
    v_pk_fma_f32 v[114:115], v[114:115], v[48:49], v[48:49] op_sel:[0,1,0] op_sel_hi:[1,1,0]
    v_cvt_pk_bf16_f32 v112, v184, v112
    v_cvt_pk_bf16_f32 v113, v185, v113
    v_cvt_pk_bf16_f32 v114, v186, v114
    v_cvt_pk_bf16_f32 v115, v187, v115
    v_pk_fma_f32 v[188:189], v[188:189], v[48:49], v[48:49] op_sel:[0,1,0] op_sel_hi:[1,1,0]
    v_pk_fma_f32 v[116:117], v[116:117], v[48:49], v[48:49] op_sel:[0,1,0] op_sel_hi:[1,1,0]
    v_pk_fma_f32 v[190:191], v[190:191], v[48:49], v[48:49] op_sel:[0,1,0] op_sel_hi:[1,1,0]
    v_pk_fma_f32 v[118:119], v[118:119], v[48:49], v[48:49] op_sel:[0,1,0] op_sel_hi:[1,1,0]
    v_cvt_pk_bf16_f32 v116, v188, v116
    v_cvt_pk_bf16_f32 v117, v189, v117
    v_cvt_pk_bf16_f32 v118, v190, v118
    v_cvt_pk_bf16_f32 v119, v191, v119
    s_waitcnt lgkmcnt(0)
    s_barrier
    ds_read_b64_tr_b16 v[200:201], v16 offset:0
    ds_read_b64_tr_b16 v[202:203], v16 offset:1792
    ds_read_b64_tr_b16 v[204:205], v16 offset:32
    ds_read_b64_tr_b16 v[206:207], v16 offset:1824
    ds_read_b64_tr_b16 v[208:209], v16 offset:64
    ds_read_b64_tr_b16 v[210:211], v16 offset:1856
    ds_read_b64_tr_b16 v[212:213], v16 offset:96
    ds_read_b64_tr_b16 v[214:215], v16 offset:1888
    ds_read_b64_tr_b16 v[216:217], v16 offset:128
    ds_read_b64_tr_b16 v[218:219], v16 offset:1920
    ds_read_b64_tr_b16 v[220:221], v16 offset:160
    ds_read_b64_tr_b16 v[222:223], v16 offset:1952
    ds_read_b64_tr_b16 v[224:225], v16 offset:192
    ds_read_b64_tr_b16 v[226:227], v16 offset:1984
    s_waitcnt lgkmcnt(10)
    v_mfma_f32_16x16x32_bf16 v[128:131], v[200:203], v[56:59], 0
    ds_read_b64_tr_b16 v[228:229], v16 offset:7168
    ds_read_b64_tr_b16 v[230:231], v16 offset:8960
    v_mfma_f32_16x16x32_bf16 v[132:135], v[204:207], v[56:59], 0
    ds_read_b64_tr_b16 v[232:233], v16 offset:7200
    ds_read_b64_tr_b16 v[234:235], v16 offset:8992
    s_waitcnt lgkmcnt(10)
    v_mfma_f32_16x16x32_bf16 v[136:139], v[208:211], v[56:59], 0
    ds_read_b64_tr_b16 v[236:237], v16 offset:7232
    ds_read_b64_tr_b16 v[238:239], v16 offset:9024
    v_mfma_f32_16x16x32_bf16 v[140:143], v[212:215], v[56:59], 0
    ds_read_b64_tr_b16 v[240:241], v16 offset:7264
    ds_read_b64_tr_b16 v[242:243], v16 offset:9056
    s_waitcnt lgkmcnt(8)
    v_mfma_f32_16x16x32_bf16 v[144:147], v[216:219], v[56:59], 0
    ds_read_b64_tr_b16 v[244:245], v16 offset:7296
    ds_read_b64_tr_b16 v[246:247], v16 offset:9088
    v_mfma_f32_16x16x32_bf16 v[148:151], v[220:223], v[56:59], 0
    ds_read_b64_tr_b16 v[248:249], v16 offset:7328
    ds_read_b64_tr_b16 v[250:251], v16 offset:9120
    v_mfma_f32_16x16x32_bf16 v[152:155], v[224:227], v[56:59], 0
    ds_read_b64_tr_b16 v[252:253], v16 offset:7360
    ds_read_b64_tr_b16 v[254:255], v16 offset:9152
    s_waitcnt lgkmcnt(10)
    v_mfma_f32_16x16x32_bf16 v[128:131], v[228:231], v[60:63], v[128:131]
    ds_read_b64_tr_b16 v[200:201], v16 offset:14336
    ds_read_b64_tr_b16 v[202:203], v16 offset:16128
    v_mfma_f32_16x16x32_bf16 v[132:135], v[232:235], v[60:63], v[132:135]
    ds_read_b64_tr_b16 v[204:205], v16 offset:14368
    ds_read_b64_tr_b16 v[206:207], v16 offset:16160
    s_waitcnt lgkmcnt(10)
    v_mfma_f32_16x16x32_bf16 v[136:139], v[236:239], v[60:63], v[136:139]
    ds_read_b64_tr_b16 v[208:209], v16 offset:14400
    ds_read_b64_tr_b16 v[210:211], v16 offset:16192
    v_mfma_f32_16x16x32_bf16 v[140:143], v[240:243], v[60:63], v[140:143]
    ds_read_b64_tr_b16 v[212:213], v16 offset:14432
    ds_read_b64_tr_b16 v[214:215], v16 offset:16224
    s_waitcnt lgkmcnt(8)
    v_mfma_f32_16x16x32_bf16 v[144:147], v[244:247], v[60:63], v[144:147]
    ds_read_b64_tr_b16 v[216:217], v16 offset:14464
    ds_read_b64_tr_b16 v[218:219], v16 offset:16256
    v_mfma_f32_16x16x32_bf16 v[148:151], v[248:251], v[60:63], v[148:151]
    ds_read_b64_tr_b16 v[220:221], v16 offset:14496
    ds_read_b64_tr_b16 v[222:223], v16 offset:16288
    v_mfma_f32_16x16x32_bf16 v[152:155], v[252:255], v[60:63], v[152:155]
    ds_read_b64_tr_b16 v[224:225], v16 offset:14528
    ds_read_b64_tr_b16 v[226:227], v16 offset:16320
    s_waitcnt lgkmcnt(10)
    v_mfma_f32_16x16x32_bf16 v[128:131], v[200:203], v[64:67], v[128:131]
    ds_read_b64_tr_b16 v[228:229], v16 offset:21504
    ds_read_b64_tr_b16 v[230:231], v16 offset:23296
    v_mfma_f32_16x16x32_bf16 v[132:135], v[204:207], v[64:67], v[132:135]
    ds_read_b64_tr_b16 v[232:233], v16 offset:21536
    ds_read_b64_tr_b16 v[234:235], v16 offset:23328
    s_waitcnt lgkmcnt(10)
    v_mfma_f32_16x16x32_bf16 v[136:139], v[208:211], v[64:67], v[136:139]
    ds_read_b64_tr_b16 v[236:237], v16 offset:21568
    ds_read_b64_tr_b16 v[238:239], v16 offset:23360
    v_mfma_f32_16x16x32_bf16 v[140:143], v[212:215], v[64:67], v[140:143]
    ds_read_b64_tr_b16 v[240:241], v16 offset:21600
    ds_read_b64_tr_b16 v[242:243], v16 offset:23392
    s_waitcnt lgkmcnt(8)
    v_mfma_f32_16x16x32_bf16 v[144:147], v[216:219], v[64:67], v[144:147]
    ds_read_b64_tr_b16 v[244:245], v16 offset:21632
    ds_read_b64_tr_b16 v[246:247], v16 offset:23424
    v_mfma_f32_16x16x32_bf16 v[148:151], v[220:223], v[64:67], v[148:151]
    ds_read_b64_tr_b16 v[248:249], v16 offset:21664
    ds_read_b64_tr_b16 v[250:251], v16 offset:23456
    v_mfma_f32_16x16x32_bf16 v[152:155], v[224:227], v[64:67], v[152:155]
    ds_read_b64_tr_b16 v[252:253], v16 offset:21696
    ds_read_b64_tr_b16 v[254:255], v16 offset:23488
    s_barrier
    s_waitcnt lgkmcnt(10)
    v_mfma_f32_16x16x32_bf16 v[128:131], v[228:231], v[68:71], v[128:131]
    ds_read_b64_tr_b16 v[200:201], v16 offset:28672
    ds_read_b64_tr_b16 v[202:203], v16 offset:30464
    v_mfma_f32_16x16x32_bf16 v[132:135], v[232:235], v[68:71], v[132:135]
    ds_read_b64_tr_b16 v[204:205], v16 offset:28704
    ds_read_b64_tr_b16 v[206:207], v16 offset:30496
    s_waitcnt lgkmcnt(10)
    v_mfma_f32_16x16x32_bf16 v[136:139], v[236:239], v[68:71], v[136:139]
    ds_read_b64_tr_b16 v[208:209], v16 offset:28736
    ds_read_b64_tr_b16 v[210:211], v16 offset:30528
    v_mfma_f32_16x16x32_bf16 v[140:143], v[240:243], v[68:71], v[140:143]
    ds_read_b64_tr_b16 v[212:213], v16 offset:28768
    ds_read_b64_tr_b16 v[214:215], v16 offset:30560
    s_waitcnt lgkmcnt(8)
    v_mfma_f32_16x16x32_bf16 v[144:147], v[244:247], v[68:71], v[144:147]
    ds_read_b64_tr_b16 v[216:217], v16 offset:28800
    ds_read_b64_tr_b16 v[218:219], v16 offset:30592
    v_mfma_f32_16x16x32_bf16 v[148:151], v[248:251], v[68:71], v[148:151]
    ds_read_b64_tr_b16 v[220:221], v16 offset:28832
    ds_read_b64_tr_b16 v[222:223], v16 offset:30624
    v_mfma_f32_16x16x32_bf16 v[152:155], v[252:255], v[68:71], v[152:155]
    ds_read_b64_tr_b16 v[224:225], v16 offset:28864
    ds_read_b64_tr_b16 v[226:227], v16 offset:30656
    s_waitcnt lgkmcnt(10)
    v_mfma_f32_16x16x32_bf16 v[128:131], v[200:203], v[72:75], v[128:131]
    ds_read_b64_tr_b16 v[228:229], v16 offset:35840
    ds_read_b64_tr_b16 v[230:231], v16 offset:37632
    v_mfma_f32_16x16x32_bf16 v[132:135], v[204:207], v[72:75], v[132:135]
    ds_read_b64_tr_b16 v[232:233], v16 offset:35872
    ds_read_b64_tr_b16 v[234:235], v16 offset:37664
    s_waitcnt lgkmcnt(10)
    v_mfma_f32_16x16x32_bf16 v[136:139], v[208:211], v[72:75], v[136:139]
    ds_read_b64_tr_b16 v[236:237], v16 offset:35904
    ds_read_b64_tr_b16 v[238:239], v16 offset:37696
    v_mfma_f32_16x16x32_bf16 v[140:143], v[212:215], v[72:75], v[140:143]
    ds_read_b64_tr_b16 v[240:241], v16 offset:35936
    ds_read_b64_tr_b16 v[242:243], v16 offset:37728
    s_waitcnt lgkmcnt(8)
    v_mfma_f32_16x16x32_bf16 v[144:147], v[216:219], v[72:75], v[144:147]
    ds_read_b64_tr_b16 v[244:245], v16 offset:35968
    ds_read_b64_tr_b16 v[246:247], v16 offset:37760
    v_mfma_f32_16x16x32_bf16 v[148:151], v[220:223], v[72:75], v[148:151]
    ds_read_b64_tr_b16 v[248:249], v16 offset:36000
    ds_read_b64_tr_b16 v[250:251], v16 offset:37792
    v_mfma_f32_16x16x32_bf16 v[152:155], v[224:227], v[72:75], v[152:155]
    ds_read_b64_tr_b16 v[252:253], v16 offset:36032
    ds_read_b64_tr_b16 v[254:255], v16 offset:37824
    s_waitcnt lgkmcnt(10)
    v_mfma_f32_16x16x32_bf16 v[128:131], v[228:231], v[76:79], v[128:131]
    ds_read_b64_tr_b16 v[200:201], v16 offset:43008
    ds_read_b64_tr_b16 v[202:203], v16 offset:44800
    v_mfma_f32_16x16x32_bf16 v[132:135], v[232:235], v[76:79], v[132:135]
    ds_read_b64_tr_b16 v[204:205], v16 offset:43040
    ds_read_b64_tr_b16 v[206:207], v16 offset:44832
    s_waitcnt lgkmcnt(10)
    v_mfma_f32_16x16x32_bf16 v[136:139], v[236:239], v[76:79], v[136:139]
    ds_read_b64_tr_b16 v[208:209], v16 offset:43072
    ds_read_b64_tr_b16 v[210:211], v16 offset:44864
    v_mfma_f32_16x16x32_bf16 v[140:143], v[240:243], v[76:79], v[140:143]
    ds_read_b64_tr_b16 v[212:213], v16 offset:43104
    ds_read_b64_tr_b16 v[214:215], v16 offset:44896
    s_waitcnt lgkmcnt(8)
    v_mfma_f32_16x16x32_bf16 v[144:147], v[244:247], v[76:79], v[144:147]
    ds_read_b64_tr_b16 v[216:217], v16 offset:43136
    ds_read_b64_tr_b16 v[218:219], v16 offset:44928
    v_mfma_f32_16x16x32_bf16 v[148:151], v[248:251], v[76:79], v[148:151]
    ds_read_b64_tr_b16 v[220:221], v16 offset:43168
    ds_read_b64_tr_b16 v[222:223], v16 offset:44960
    v_mfma_f32_16x16x32_bf16 v[152:155], v[252:255], v[76:79], v[152:155]
    ds_read_b64_tr_b16 v[224:225], v16 offset:43200
    ds_read_b64_tr_b16 v[226:227], v16 offset:44992
    s_waitcnt lgkmcnt(10)
    v_mfma_f32_16x16x32_bf16 v[128:131], v[200:203], v[80:83], v[128:131]
    ds_read_b64_tr_b16 v[228:229], v16 offset:50176
    ds_read_b64_tr_b16 v[230:231], v16 offset:51968
    v_mfma_f32_16x16x32_bf16 v[132:135], v[204:207], v[80:83], v[132:135]
    ds_read_b64_tr_b16 v[232:233], v16 offset:50208
    ds_read_b64_tr_b16 v[234:235], v16 offset:52000
    s_waitcnt lgkmcnt(10)
    v_mfma_f32_16x16x32_bf16 v[136:139], v[208:211], v[80:83], v[136:139]
    ds_read_b64_tr_b16 v[236:237], v16 offset:50240
    ds_read_b64_tr_b16 v[238:239], v16 offset:52032
    v_mfma_f32_16x16x32_bf16 v[140:143], v[212:215], v[80:83], v[140:143]
    ds_read_b64_tr_b16 v[240:241], v16 offset:50272
    ds_read_b64_tr_b16 v[242:243], v16 offset:52064
    s_waitcnt lgkmcnt(8)
    v_mfma_f32_16x16x32_bf16 v[144:147], v[216:219], v[80:83], v[144:147]
    ds_read_b64_tr_b16 v[244:245], v16 offset:50304
    ds_read_b64_tr_b16 v[246:247], v16 offset:52096
    v_mfma_f32_16x16x32_bf16 v[148:151], v[220:223], v[80:83], v[148:151]
    ds_read_b64_tr_b16 v[248:249], v16 offset:50336
    ds_read_b64_tr_b16 v[250:251], v16 offset:52128
    v_mfma_f32_16x16x32_bf16 v[152:155], v[224:227], v[80:83], v[152:155]
    ds_read_b64_tr_b16 v[252:253], v16 offset:50368
    ds_read_b64_tr_b16 v[254:255], v16 offset:52160
    s_barrier
    s_waitcnt lgkmcnt(10)
    v_mfma_f32_16x16x32_bf16 v[128:131], v[228:231], v[84:87], v[128:131]
    ds_read_b64_tr_b16 v[200:201], v17 offset:0
    ds_read_b64_tr_b16 v[202:203], v17 offset:1792
    v_mfma_f32_16x16x32_bf16 v[132:135], v[232:235], v[84:87], v[132:135]
    ds_read_b64_tr_b16 v[204:205], v17 offset:32
    ds_read_b64_tr_b16 v[206:207], v17 offset:1824
    s_waitcnt lgkmcnt(10)
    v_mfma_f32_16x16x32_bf16 v[136:139], v[236:239], v[84:87], v[136:139]
    ds_read_b64_tr_b16 v[208:209], v17 offset:64
    ds_read_b64_tr_b16 v[210:211], v17 offset:1856
    v_mfma_f32_16x16x32_bf16 v[140:143], v[240:243], v[84:87], v[140:143]
    ds_read_b64_tr_b16 v[212:213], v17 offset:96
    ds_read_b64_tr_b16 v[214:215], v17 offset:1888
    s_waitcnt lgkmcnt(8)
    v_mfma_f32_16x16x32_bf16 v[144:147], v[244:247], v[84:87], v[144:147]
    ds_read_b64_tr_b16 v[216:217], v17 offset:128
    ds_read_b64_tr_b16 v[218:219], v17 offset:1920
    v_mfma_f32_16x16x32_bf16 v[148:151], v[248:251], v[84:87], v[148:151]
    ds_read_b64_tr_b16 v[220:221], v17 offset:160
    ds_read_b64_tr_b16 v[222:223], v17 offset:1952
    v_mfma_f32_16x16x32_bf16 v[152:155], v[252:255], v[84:87], v[152:155]
    ds_read_b64_tr_b16 v[224:225], v17 offset:192
    ds_read_b64_tr_b16 v[226:227], v17 offset:1984
    s_waitcnt lgkmcnt(10)
    v_mfma_f32_16x16x32_bf16 v[128:131], v[200:203], v[88:91], v[128:131]
    ds_read_b64_tr_b16 v[228:229], v17 offset:7168
    ds_read_b64_tr_b16 v[230:231], v17 offset:8960
    v_mfma_f32_16x16x32_bf16 v[132:135], v[204:207], v[88:91], v[132:135]
    ds_read_b64_tr_b16 v[232:233], v17 offset:7200
    ds_read_b64_tr_b16 v[234:235], v17 offset:8992
    s_waitcnt lgkmcnt(10)
    v_mfma_f32_16x16x32_bf16 v[136:139], v[208:211], v[88:91], v[136:139]
    ds_read_b64_tr_b16 v[236:237], v17 offset:7232
    ds_read_b64_tr_b16 v[238:239], v17 offset:9024
    v_mfma_f32_16x16x32_bf16 v[140:143], v[212:215], v[88:91], v[140:143]
    ds_read_b64_tr_b16 v[240:241], v17 offset:7264
    ds_read_b64_tr_b16 v[242:243], v17 offset:9056
    s_waitcnt lgkmcnt(8)
    v_mfma_f32_16x16x32_bf16 v[144:147], v[216:219], v[88:91], v[144:147]
    ds_read_b64_tr_b16 v[244:245], v17 offset:7296
    ds_read_b64_tr_b16 v[246:247], v17 offset:9088
    v_mfma_f32_16x16x32_bf16 v[148:151], v[220:223], v[88:91], v[148:151]
    ds_read_b64_tr_b16 v[248:249], v17 offset:7328
    ds_read_b64_tr_b16 v[250:251], v17 offset:9120
    v_mfma_f32_16x16x32_bf16 v[152:155], v[224:227], v[88:91], v[152:155]
    ds_read_b64_tr_b16 v[252:253], v17 offset:7360
    ds_read_b64_tr_b16 v[254:255], v17 offset:9152
    s_waitcnt lgkmcnt(10)
    v_mfma_f32_16x16x32_bf16 v[128:131], v[228:231], v[92:95], v[128:131]
    ds_read_b64_tr_b16 v[200:201], v17 offset:14336
    ds_read_b64_tr_b16 v[202:203], v17 offset:16128
    v_mfma_f32_16x16x32_bf16 v[132:135], v[232:235], v[92:95], v[132:135]
    ds_read_b64_tr_b16 v[204:205], v17 offset:14368
    ds_read_b64_tr_b16 v[206:207], v17 offset:16160
    s_waitcnt lgkmcnt(10)
    v_mfma_f32_16x16x32_bf16 v[136:139], v[236:239], v[92:95], v[136:139]
    ds_read_b64_tr_b16 v[208:209], v17 offset:14400
    ds_read_b64_tr_b16 v[210:211], v17 offset:16192
    v_mfma_f32_16x16x32_bf16 v[140:143], v[240:243], v[92:95], v[140:143]
    ds_read_b64_tr_b16 v[212:213], v17 offset:14432
    ds_read_b64_tr_b16 v[214:215], v17 offset:16224
    s_waitcnt lgkmcnt(8)
    v_mfma_f32_16x16x32_bf16 v[144:147], v[244:247], v[92:95], v[144:147]
    ds_read_b64_tr_b16 v[216:217], v17 offset:14464
    ds_read_b64_tr_b16 v[218:219], v17 offset:16256
    v_mfma_f32_16x16x32_bf16 v[148:151], v[248:251], v[92:95], v[148:151]
    ds_read_b64_tr_b16 v[220:221], v17 offset:14496
    ds_read_b64_tr_b16 v[222:223], v17 offset:16288
    v_mfma_f32_16x16x32_bf16 v[152:155], v[252:255], v[92:95], v[152:155]
    ds_read_b64_tr_b16 v[224:225], v17 offset:14528
    ds_read_b64_tr_b16 v[226:227], v17 offset:16320
    s_waitcnt lgkmcnt(10)
    v_mfma_f32_16x16x32_bf16 v[128:131], v[200:203], v[96:99], v[128:131]
    ds_read_b64_tr_b16 v[228:229], v17 offset:21504
    ds_read_b64_tr_b16 v[230:231], v17 offset:23296
    v_mfma_f32_16x16x32_bf16 v[132:135], v[204:207], v[96:99], v[132:135]
    ds_read_b64_tr_b16 v[232:233], v17 offset:21536
    ds_read_b64_tr_b16 v[234:235], v17 offset:23328
    s_waitcnt lgkmcnt(10)
    v_mfma_f32_16x16x32_bf16 v[136:139], v[208:211], v[96:99], v[136:139]
    ds_read_b64_tr_b16 v[236:237], v17 offset:21568
    ds_read_b64_tr_b16 v[238:239], v17 offset:23360
    v_mfma_f32_16x16x32_bf16 v[140:143], v[212:215], v[96:99], v[140:143]
    ds_read_b64_tr_b16 v[240:241], v17 offset:21600
    ds_read_b64_tr_b16 v[242:243], v17 offset:23392
    s_waitcnt lgkmcnt(8)
    v_mfma_f32_16x16x32_bf16 v[144:147], v[216:219], v[96:99], v[144:147]
    ds_read_b64_tr_b16 v[244:245], v17 offset:21632
    ds_read_b64_tr_b16 v[246:247], v17 offset:23424
    v_mfma_f32_16x16x32_bf16 v[148:151], v[220:223], v[96:99], v[148:151]
    ds_read_b64_tr_b16 v[248:249], v17 offset:21664
    ds_read_b64_tr_b16 v[250:251], v17 offset:23456
    v_mfma_f32_16x16x32_bf16 v[152:155], v[224:227], v[96:99], v[152:155]
    ds_read_b64_tr_b16 v[252:253], v17 offset:21696
    ds_read_b64_tr_b16 v[254:255], v17 offset:23488
    s_barrier
    s_waitcnt lgkmcnt(10)
    v_mfma_f32_16x16x32_bf16 v[128:131], v[228:231], v[100:103], v[128:131]
    ds_read_b64_tr_b16 v[200:201], v17 offset:28672
    ds_read_b64_tr_b16 v[202:203], v17 offset:30464
    v_mfma_f32_16x16x32_bf16 v[132:135], v[232:235], v[100:103], v[132:135]
    ds_read_b64_tr_b16 v[204:205], v17 offset:28704
    ds_read_b64_tr_b16 v[206:207], v17 offset:30496
    s_waitcnt lgkmcnt(10)
    v_mfma_f32_16x16x32_bf16 v[136:139], v[236:239], v[100:103], v[136:139]
    ds_read_b64_tr_b16 v[208:209], v17 offset:28736
    ds_read_b64_tr_b16 v[210:211], v17 offset:30528
    v_mfma_f32_16x16x32_bf16 v[140:143], v[240:243], v[100:103], v[140:143]
    ds_read_b64_tr_b16 v[212:213], v17 offset:28768
    ds_read_b64_tr_b16 v[214:215], v17 offset:30560
    s_waitcnt lgkmcnt(8)
    v_mfma_f32_16x16x32_bf16 v[144:147], v[244:247], v[100:103], v[144:147]
    ds_read_b64_tr_b16 v[216:217], v17 offset:28800
    ds_read_b64_tr_b16 v[218:219], v17 offset:30592
    v_mfma_f32_16x16x32_bf16 v[148:151], v[248:251], v[100:103], v[148:151]
    ds_read_b64_tr_b16 v[220:221], v17 offset:28832
    ds_read_b64_tr_b16 v[222:223], v17 offset:30624
    v_mfma_f32_16x16x32_bf16 v[152:155], v[252:255], v[100:103], v[152:155]
    ds_read_b64_tr_b16 v[224:225], v17 offset:28864
    ds_read_b64_tr_b16 v[226:227], v17 offset:30656
    s_waitcnt lgkmcnt(10)
    v_mfma_f32_16x16x32_bf16 v[128:131], v[200:203], v[104:107], v[128:131]
    ds_read_b64_tr_b16 v[228:229], v17 offset:35840
    ds_read_b64_tr_b16 v[230:231], v17 offset:37632
    v_mfma_f32_16x16x32_bf16 v[132:135], v[204:207], v[104:107], v[132:135]
    ds_read_b64_tr_b16 v[232:233], v17 offset:35872
    ds_read_b64_tr_b16 v[234:235], v17 offset:37664
    s_waitcnt lgkmcnt(10)
    v_mfma_f32_16x16x32_bf16 v[136:139], v[208:211], v[104:107], v[136:139]
    ds_read_b64_tr_b16 v[236:237], v17 offset:35904
    ds_read_b64_tr_b16 v[238:239], v17 offset:37696
    v_mfma_f32_16x16x32_bf16 v[140:143], v[212:215], v[104:107], v[140:143]
    ds_read_b64_tr_b16 v[240:241], v17 offset:35936
    ds_read_b64_tr_b16 v[242:243], v17 offset:37728
    s_waitcnt lgkmcnt(8)
    v_mfma_f32_16x16x32_bf16 v[144:147], v[216:219], v[104:107], v[144:147]
    ds_read_b64_tr_b16 v[244:245], v17 offset:35968
    ds_read_b64_tr_b16 v[246:247], v17 offset:37760
    v_mfma_f32_16x16x32_bf16 v[148:151], v[220:223], v[104:107], v[148:151]
    ds_read_b64_tr_b16 v[248:249], v17 offset:36000
    ds_read_b64_tr_b16 v[250:251], v17 offset:37792
    v_mfma_f32_16x16x32_bf16 v[152:155], v[224:227], v[104:107], v[152:155]
    ds_read_b64_tr_b16 v[252:253], v17 offset:36032
    ds_read_b64_tr_b16 v[254:255], v17 offset:37824
    s_waitcnt lgkmcnt(10)
    v_mfma_f32_16x16x32_bf16 v[128:131], v[228:231], v[108:111], v[128:131]
    ds_read_b64_tr_b16 v[200:201], v17 offset:43008
    ds_read_b64_tr_b16 v[202:203], v17 offset:44800
    v_mfma_f32_16x16x32_bf16 v[132:135], v[232:235], v[108:111], v[132:135]
    ds_read_b64_tr_b16 v[204:205], v17 offset:43040
    ds_read_b64_tr_b16 v[206:207], v17 offset:44832
    s_waitcnt lgkmcnt(10)
    v_mfma_f32_16x16x32_bf16 v[136:139], v[236:239], v[108:111], v[136:139]
    ds_read_b64_tr_b16 v[208:209], v17 offset:43072
    ds_read_b64_tr_b16 v[210:211], v17 offset:44864
    v_mfma_f32_16x16x32_bf16 v[140:143], v[240:243], v[108:111], v[140:143]
    ds_read_b64_tr_b16 v[212:213], v17 offset:43104
    ds_read_b64_tr_b16 v[214:215], v17 offset:44896
    s_waitcnt lgkmcnt(8)
    v_mfma_f32_16x16x32_bf16 v[144:147], v[244:247], v[108:111], v[144:147]
    ds_read_b64_tr_b16 v[216:217], v17 offset:43136
    ds_read_b64_tr_b16 v[218:219], v17 offset:44928
    v_mfma_f32_16x16x32_bf16 v[148:151], v[248:251], v[108:111], v[148:151]
    ds_read_b64_tr_b16 v[220:221], v17 offset:43168
    ds_read_b64_tr_b16 v[222:223], v17 offset:44960
    v_mfma_f32_16x16x32_bf16 v[152:155], v[252:255], v[108:111], v[152:155]
    ds_read_b64_tr_b16 v[224:225], v17 offset:43200
    ds_read_b64_tr_b16 v[226:227], v17 offset:44992
    s_waitcnt lgkmcnt(10)
    v_mfma_f32_16x16x32_bf16 v[128:131], v[200:203], v[112:115], v[128:131]
    ds_read_b64_tr_b16 v[228:229], v17 offset:50176
    ds_read_b64_tr_b16 v[230:231], v17 offset:51968
    v_mfma_f32_16x16x32_bf16 v[132:135], v[204:207], v[112:115], v[132:135]
    ds_read_b64_tr_b16 v[232:233], v17 offset:50208
    ds_read_b64_tr_b16 v[234:235], v17 offset:52000
    s_waitcnt lgkmcnt(10)
    v_mfma_f32_16x16x32_bf16 v[136:139], v[208:211], v[112:115], v[136:139]
    ds_read_b64_tr_b16 v[236:237], v17 offset:50240
    ds_read_b64_tr_b16 v[238:239], v17 offset:52032
    v_mfma_f32_16x16x32_bf16 v[140:143], v[212:215], v[112:115], v[140:143]
    ds_read_b64_tr_b16 v[240:241], v17 offset:50272
    ds_read_b64_tr_b16 v[242:243], v17 offset:52064
    s_waitcnt lgkmcnt(8)
    v_mfma_f32_16x16x32_bf16 v[144:147], v[216:219], v[112:115], v[144:147]
    ds_read_b64_tr_b16 v[244:245], v17 offset:50304
    ds_read_b64_tr_b16 v[246:247], v17 offset:52096
    v_mfma_f32_16x16x32_bf16 v[148:151], v[220:223], v[112:115], v[148:151]
    ds_read_b64_tr_b16 v[248:249], v17 offset:50336
    ds_read_b64_tr_b16 v[250:251], v17 offset:52128
    v_mfma_f32_16x16x32_bf16 v[152:155], v[224:227], v[112:115], v[152:155]
    ds_read_b64_tr_b16 v[252:253], v17 offset:50368
    ds_read_b64_tr_b16 v[254:255], v17 offset:52160
    s_waitcnt lgkmcnt(12)
    v_mfma_f32_16x16x32_bf16 v[128:131], v[228:231], v[116:119], v[128:131]
    s_waitcnt lgkmcnt(10)
    v_mfma_f32_16x16x32_bf16 v[132:135], v[232:235], v[116:119], v[132:135]
    s_waitcnt lgkmcnt(8)
    v_mfma_f32_16x16x32_bf16 v[136:139], v[236:239], v[116:119], v[136:139]
    s_waitcnt lgkmcnt(6)
    v_mfma_f32_16x16x32_bf16 v[140:143], v[240:243], v[116:119], v[140:143]
    s_waitcnt lgkmcnt(4)
    v_mfma_f32_16x16x32_bf16 v[144:147], v[244:247], v[116:119], v[144:147]
    s_waitcnt lgkmcnt(2)
    v_mfma_f32_16x16x32_bf16 v[148:151], v[248:251], v[116:119], v[148:151]
    s_waitcnt lgkmcnt(0)
    v_mfma_f32_16x16x32_bf16 v[152:155], v[252:255], v[116:119], v[152:155]
    s_barrier
    v_pk_mul_f32 v[184:185], v[128:129], v[128:129]
    v_pk_mul_f32 v[186:187], v[130:131], v[130:131]
    v_pk_mul_f32 v[188:189], v[132:133], v[132:133]
    v_pk_mul_f32 v[190:191], v[134:135], v[134:135]
    v_pk_fma_f32 v[184:185], v[184:185], s[38:39], s[38:39] op_sel:[0,1,0] op_sel_hi:[1,1,0]
    v_pk_fma_f32 v[186:187], v[186:187], s[38:39], s[38:39] op_sel:[0,1,0] op_sel_hi:[1,1,0]
    v_pk_fma_f32 v[188:189], v[188:189], s[38:39], s[38:39] op_sel:[0,1,0] op_sel_hi:[1,1,0]
    v_pk_fma_f32 v[190:191], v[190:191], s[38:39], s[38:39] op_sel:[0,1,0] op_sel_hi:[1,1,0]
    v_pk_mul_f32 v[184:185], v[184:185], v[128:129]
    v_pk_mul_f32 v[186:187], v[186:187], v[130:131]
    v_pk_mul_f32 v[188:189], v[188:189], v[132:133]
    v_pk_mul_f32 v[190:191], v[190:191], v[134:135]
    v_exp_f32 v184, v184
    v_exp_f32 v185, v185
    v_exp_f32 v186, v186
    v_exp_f32 v187, v187
    v_exp_f32 v188, v188
    v_exp_f32 v189, v189
    v_exp_f32 v190, v190
    v_exp_f32 v191, v191
    v_pk_add_f32 v[184:185], v[184:185], 1.0 op_sel_hi:[1,0]
    v_pk_add_f32 v[186:187], v[186:187], 1.0 op_sel_hi:[1,0]
    v_pk_add_f32 v[188:189], v[188:189], 1.0 op_sel_hi:[1,0]
    v_pk_add_f32 v[190:191], v[190:191], 1.0 op_sel_hi:[1,0]
    v_rcp_f32 v184, v184
    v_rcp_f32 v185, v185
    v_rcp_f32 v186, v186
    v_rcp_f32 v187, v187
    v_rcp_f32 v188, v188
    v_rcp_f32 v189, v189
    v_rcp_f32 v190, v190
    v_rcp_f32 v191, v191
    v_pk_mul_f32 v[128:129], v[184:185], v[128:129]
    v_pk_mul_f32 v[130:131], v[186:187], v[130:131]
    v_pk_mul_f32 v[132:133], v[188:189], v[132:133]
    v_pk_mul_f32 v[134:135], v[190:191], v[134:135]
    v_pk_mul_f32 v[50:51], v[128:129], v[128:129]
    v_pk_fma_f32 v[50:51], v[130:131], v[130:131], v[50:51]
    v_pk_add_f32 v[48:49], v[128:129], v[130:131]
    v_pk_fma_f32 v[50:51], v[132:133], v[132:133], v[50:51]
    v_pk_add_f32 v[48:49], v[48:49], v[132:133]
    v_pk_fma_f32 v[50:51], v[134:135], v[134:135], v[50:51]
    v_pk_add_f32 v[48:49], v[48:49], v[134:135]
    v_pk_mul_f32 v[192:193], v[136:137], v[136:137]
    v_pk_mul_f32 v[194:195], v[138:139], v[138:139]
    v_pk_mul_f32 v[196:197], v[140:141], v[140:141]
    v_pk_mul_f32 v[198:199], v[142:143], v[142:143]
    v_pk_fma_f32 v[192:193], v[192:193], s[38:39], s[38:39] op_sel:[0,1,0] op_sel_hi:[1,1,0]
    v_pk_fma_f32 v[194:195], v[194:195], s[38:39], s[38:39] op_sel:[0,1,0] op_sel_hi:[1,1,0]
    v_pk_fma_f32 v[196:197], v[196:197], s[38:39], s[38:39] op_sel:[0,1,0] op_sel_hi:[1,1,0]
    v_pk_fma_f32 v[198:199], v[198:199], s[38:39], s[38:39] op_sel:[0,1,0] op_sel_hi:[1,1,0]
    v_pk_mul_f32 v[192:193], v[192:193], v[136:137]
    v_pk_mul_f32 v[194:195], v[194:195], v[138:139]
    v_pk_mul_f32 v[196:197], v[196:197], v[140:141]
    v_pk_mul_f32 v[198:199], v[198:199], v[142:143]
    v_exp_f32 v192, v192
    v_exp_f32 v193, v193
    v_exp_f32 v194, v194
    v_exp_f32 v195, v195
    v_exp_f32 v196, v196
    v_exp_f32 v197, v197
    v_exp_f32 v198, v198
    v_exp_f32 v199, v199
    v_pk_add_f32 v[192:193], v[192:193], 1.0 op_sel_hi:[1,0]
    v_pk_add_f32 v[194:195], v[194:195], 1.0 op_sel_hi:[1,0]
    v_pk_add_f32 v[196:197], v[196:197], 1.0 op_sel_hi:[1,0]
    v_pk_add_f32 v[198:199], v[198:199], 1.0 op_sel_hi:[1,0]
    v_rcp_f32 v192, v192
    v_rcp_f32 v193, v193
    v_rcp_f32 v194, v194
    v_rcp_f32 v195, v195
    v_rcp_f32 v196, v196
    v_rcp_f32 v197, v197
    v_rcp_f32 v198, v198
    v_rcp_f32 v199, v199
    v_pk_mul_f32 v[136:137], v[192:193], v[136:137]
    v_pk_mul_f32 v[138:139], v[194:195], v[138:139]
    v_pk_mul_f32 v[140:141], v[196:197], v[140:141]
    v_pk_mul_f32 v[142:143], v[198:199], v[142:143]
    v_pk_fma_f32 v[50:51], v[136:137], v[136:137], v[50:51]
    v_pk_add_f32 v[48:49], v[48:49], v[136:137]
    v_pk_fma_f32 v[50:51], v[138:139], v[138:139], v[50:51]
    v_pk_add_f32 v[48:49], v[48:49], v[138:139]
    v_pk_fma_f32 v[50:51], v[140:141], v[140:141], v[50:51]
    v_pk_add_f32 v[48:49], v[48:49], v[140:141]
    v_pk_fma_f32 v[50:51], v[142:143], v[142:143], v[50:51]
    v_pk_add_f32 v[48:49], v[48:49], v[142:143]
    v_pk_mul_f32 v[184:185], v[144:145], v[144:145]
    v_pk_mul_f32 v[186:187], v[146:147], v[146:147]
    v_pk_mul_f32 v[188:189], v[148:149], v[148:149]
    v_pk_mul_f32 v[190:191], v[150:151], v[150:151]
    v_pk_fma_f32 v[184:185], v[184:185], s[38:39], s[38:39] op_sel:[0,1,0] op_sel_hi:[1,1,0]
    v_pk_fma_f32 v[186:187], v[186:187], s[38:39], s[38:39] op_sel:[0,1,0] op_sel_hi:[1,1,0]
    v_pk_fma_f32 v[188:189], v[188:189], s[38:39], s[38:39] op_sel:[0,1,0] op_sel_hi:[1,1,0]
    v_pk_fma_f32 v[190:191], v[190:191], s[38:39], s[38:39] op_sel:[0,1,0] op_sel_hi:[1,1,0]
    v_pk_mul_f32 v[184:185], v[184:185], v[144:145]
    v_pk_mul_f32 v[186:187], v[186:187], v[146:147]
    v_pk_mul_f32 v[188:189], v[188:189], v[148:149]
    v_pk_mul_f32 v[190:191], v[190:191], v[150:151]
    v_exp_f32 v184, v184
    v_exp_f32 v185, v185
    v_exp_f32 v186, v186
    v_exp_f32 v187, v187
    v_exp_f32 v188, v188
    v_exp_f32 v189, v189
    v_exp_f32 v190, v190
    v_exp_f32 v191, v191
    v_pk_add_f32 v[184:185], v[184:185], 1.0 op_sel_hi:[1,0]
    v_pk_add_f32 v[186:187], v[186:187], 1.0 op_sel_hi:[1,0]
    v_pk_add_f32 v[188:189], v[188:189], 1.0 op_sel_hi:[1,0]
    v_pk_add_f32 v[190:191], v[190:191], 1.0 op_sel_hi:[1,0]
    v_rcp_f32 v184, v184
    v_rcp_f32 v185, v185
    v_rcp_f32 v186, v186
    v_rcp_f32 v187, v187
    v_rcp_f32 v188, v188
    v_rcp_f32 v189, v189
    v_rcp_f32 v190, v190
    v_rcp_f32 v191, v191
    v_pk_mul_f32 v[144:145], v[184:185], v[144:145]
    v_pk_mul_f32 v[146:147], v[186:187], v[146:147]
    v_pk_mul_f32 v[148:149], v[188:189], v[148:149]
    v_pk_mul_f32 v[150:151], v[190:191], v[150:151]
    v_pk_fma_f32 v[50:51], v[144:145], v[144:145], v[50:51]
    v_pk_add_f32 v[48:49], v[48:49], v[144:145]
    v_pk_fma_f32 v[50:51], v[146:147], v[146:147], v[50:51]
    v_pk_add_f32 v[48:49], v[48:49], v[146:147]
    v_pk_fma_f32 v[50:51], v[148:149], v[148:149], v[50:51]
    v_pk_add_f32 v[48:49], v[48:49], v[148:149]
    v_pk_fma_f32 v[50:51], v[150:151], v[150:151], v[50:51]
    v_pk_add_f32 v[48:49], v[48:49], v[150:151]
    v_pk_mul_f32 v[192:193], v[152:153], v[152:153]
    v_pk_mul_f32 v[194:195], v[154:155], v[154:155]
    v_pk_fma_f32 v[192:193], v[192:193], s[38:39], s[38:39] op_sel:[0,1,0] op_sel_hi:[1,1,0]
    v_pk_fma_f32 v[194:195], v[194:195], s[38:39], s[38:39] op_sel:[0,1,0] op_sel_hi:[1,1,0]
    v_pk_mul_f32 v[192:193], v[192:193], v[152:153]
    v_pk_mul_f32 v[194:195], v[194:195], v[154:155]
    v_exp_f32 v192, v192
    v_exp_f32 v193, v193
    v_exp_f32 v194, v194
    v_exp_f32 v195, v195
    v_pk_add_f32 v[192:193], v[192:193], 1.0 op_sel_hi:[1,0]
    v_pk_add_f32 v[194:195], v[194:195], 1.0 op_sel_hi:[1,0]
    v_rcp_f32 v192, v192
    v_rcp_f32 v193, v193
    v_rcp_f32 v194, v194
    v_rcp_f32 v195, v195
    v_pk_mul_f32 v[152:153], v[192:193], v[152:153]
    v_pk_mul_f32 v[154:155], v[194:195], v[154:155]
    v_pk_fma_f32 v[50:51], v[152:153], v[152:153], v[50:51]
    v_pk_add_f32 v[48:49], v[48:49], v[152:153]
    v_pk_fma_f32 v[50:51], v[154:155], v[154:155], v[50:51]
    v_pk_add_f32 v[48:49], v[48:49], v[154:155]
    v_add_f32 v48, v48, v49
    v_add_f32 v50, v50, v51
    v_mov_b32 v52, v48
    v_mov_b32 v53, v50
    s_nop 0
    v_permlane32_swap_b32 v48, v52
    v_permlane32_swap_b32 v50, v53
    v_add_f32 v48, v48, v52
    v_add_f32 v50, v50, v53
    v_mov_b32 v52, v48
    v_mov_b32 v53, v50
    s_nop 0
    v_permlane16_swap_b32 v48, v52
    v_permlane16_swap_b32 v50, v53
    v_add_f32 v48, v48, v52
    v_add_f32 v50, v50, v53
    v_mov_b32 v49, v2
    v_mov_b32 v51, v3
    buffer_store_dwordx4 v[48:51], v19, s[8:11], s37 offen sc1
    s_barrier
    ds_read_b64_tr_b16 v[200:201], v16 offset:0
    ds_read_b64_tr_b16 v[202:203], v16 offset:1792
    ds_read_b64_tr_b16 v[204:205], v16 offset:32
    ds_read_b64_tr_b16 v[206:207], v16 offset:1824
    ds_read_b64_tr_b16 v[208:209], v16 offset:64
    ds_read_b64_tr_b16 v[210:211], v16 offset:1856
    ds_read_b64_tr_b16 v[212:213], v16 offset:96
    ds_read_b64_tr_b16 v[214:215], v16 offset:1888
    ds_read_b64_tr_b16 v[216:217], v16 offset:128
    ds_read_b64_tr_b16 v[218:219], v16 offset:1920
    ds_read_b64_tr_b16 v[220:221], v16 offset:160
    ds_read_b64_tr_b16 v[222:223], v16 offset:1952
    ds_read_b64_tr_b16 v[224:225], v16 offset:192
    ds_read_b64_tr_b16 v[226:227], v16 offset:1984
    s_waitcnt lgkmcnt(10)
    v_mfma_f32_16x16x32_bf16 v[156:159], v[200:203], v[56:59], 0
    ds_read_b64_tr_b16 v[228:229], v16 offset:7168
    ds_read_b64_tr_b16 v[230:231], v16 offset:8960
    v_mfma_f32_16x16x32_bf16 v[160:163], v[204:207], v[56:59], 0
    ds_read_b64_tr_b16 v[232:233], v16 offset:7200
    ds_read_b64_tr_b16 v[234:235], v16 offset:8992
    s_waitcnt lgkmcnt(10)
    v_mfma_f32_16x16x32_bf16 v[164:167], v[208:211], v[56:59], 0
    ds_read_b64_tr_b16 v[236:237], v16 offset:7232
    ds_read_b64_tr_b16 v[238:239], v16 offset:9024
    v_mfma_f32_16x16x32_bf16 v[168:171], v[212:215], v[56:59], 0
    ds_read_b64_tr_b16 v[240:241], v16 offset:7264
    ds_read_b64_tr_b16 v[242:243], v16 offset:9056
    s_waitcnt lgkmcnt(8)
    v_mfma_f32_16x16x32_bf16 v[172:175], v[216:219], v[56:59], 0
    ds_read_b64_tr_b16 v[244:245], v16 offset:7296
    ds_read_b64_tr_b16 v[246:247], v16 offset:9088
    v_mfma_f32_16x16x32_bf16 v[176:179], v[220:223], v[56:59], 0
    ds_read_b64_tr_b16 v[248:249], v16 offset:7328
    ds_read_b64_tr_b16 v[250:251], v16 offset:9120
    v_mfma_f32_16x16x32_bf16 v[180:183], v[224:227], v[56:59], 0
    ds_read_b64_tr_b16 v[252:253], v16 offset:7360
    ds_read_b64_tr_b16 v[254:255], v16 offset:9152
    s_waitcnt lgkmcnt(10)
    v_mfma_f32_16x16x32_bf16 v[156:159], v[228:231], v[60:63], v[156:159]
    ds_read_b64_tr_b16 v[200:201], v16 offset:14336
    ds_read_b64_tr_b16 v[202:203], v16 offset:16128
    v_mfma_f32_16x16x32_bf16 v[160:163], v[232:235], v[60:63], v[160:163]
    ds_read_b64_tr_b16 v[204:205], v16 offset:14368
    ds_read_b64_tr_b16 v[206:207], v16 offset:16160
    s_waitcnt lgkmcnt(10)
    v_mfma_f32_16x16x32_bf16 v[164:167], v[236:239], v[60:63], v[164:167]
    ds_read_b64_tr_b16 v[208:209], v16 offset:14400
    ds_read_b64_tr_b16 v[210:211], v16 offset:16192
    v_mfma_f32_16x16x32_bf16 v[168:171], v[240:243], v[60:63], v[168:171]
    ds_read_b64_tr_b16 v[212:213], v16 offset:14432
    ds_read_b64_tr_b16 v[214:215], v16 offset:16224
    s_waitcnt lgkmcnt(8)
    v_mfma_f32_16x16x32_bf16 v[172:175], v[244:247], v[60:63], v[172:175]
    ds_read_b64_tr_b16 v[216:217], v16 offset:14464
    ds_read_b64_tr_b16 v[218:219], v16 offset:16256
    v_mfma_f32_16x16x32_bf16 v[176:179], v[248:251], v[60:63], v[176:179]
    ds_read_b64_tr_b16 v[220:221], v16 offset:14496
    ds_read_b64_tr_b16 v[222:223], v16 offset:16288
    v_mfma_f32_16x16x32_bf16 v[180:183], v[252:255], v[60:63], v[180:183]
    ds_read_b64_tr_b16 v[224:225], v16 offset:14528
    ds_read_b64_tr_b16 v[226:227], v16 offset:16320
    s_waitcnt lgkmcnt(10)
    v_mfma_f32_16x16x32_bf16 v[156:159], v[200:203], v[64:67], v[156:159]
    ds_read_b64_tr_b16 v[228:229], v16 offset:21504
    ds_read_b64_tr_b16 v[230:231], v16 offset:23296
    v_mfma_f32_16x16x32_bf16 v[160:163], v[204:207], v[64:67], v[160:163]
    ds_read_b64_tr_b16 v[232:233], v16 offset:21536
    ds_read_b64_tr_b16 v[234:235], v16 offset:23328
    s_waitcnt lgkmcnt(10)
    v_mfma_f32_16x16x32_bf16 v[164:167], v[208:211], v[64:67], v[164:167]
    ds_read_b64_tr_b16 v[236:237], v16 offset:21568
    ds_read_b64_tr_b16 v[238:239], v16 offset:23360
    v_mfma_f32_16x16x32_bf16 v[168:171], v[212:215], v[64:67], v[168:171]
    ds_read_b64_tr_b16 v[240:241], v16 offset:21600
    ds_read_b64_tr_b16 v[242:243], v16 offset:23392
    s_waitcnt lgkmcnt(8)
    v_mfma_f32_16x16x32_bf16 v[172:175], v[216:219], v[64:67], v[172:175]
    ds_read_b64_tr_b16 v[244:245], v16 offset:21632
    ds_read_b64_tr_b16 v[246:247], v16 offset:23424
    v_mfma_f32_16x16x32_bf16 v[176:179], v[220:223], v[64:67], v[176:179]
    ds_read_b64_tr_b16 v[248:249], v16 offset:21664
    ds_read_b64_tr_b16 v[250:251], v16 offset:23456
    v_mfma_f32_16x16x32_bf16 v[180:183], v[224:227], v[64:67], v[180:183]
    ds_read_b64_tr_b16 v[252:253], v16 offset:21696
    ds_read_b64_tr_b16 v[254:255], v16 offset:23488
    s_barrier
    s_waitcnt lgkmcnt(10)
    v_mfma_f32_16x16x32_bf16 v[156:159], v[228:231], v[68:71], v[156:159]
    ds_read_b64_tr_b16 v[200:201], v16 offset:28672
    ds_read_b64_tr_b16 v[202:203], v16 offset:30464
    v_mfma_f32_16x16x32_bf16 v[160:163], v[232:235], v[68:71], v[160:163]
    ds_read_b64_tr_b16 v[204:205], v16 offset:28704
    ds_read_b64_tr_b16 v[206:207], v16 offset:30496
    s_waitcnt lgkmcnt(10)
    v_mfma_f32_16x16x32_bf16 v[164:167], v[236:239], v[68:71], v[164:167]
    ds_read_b64_tr_b16 v[208:209], v16 offset:28736
    ds_read_b64_tr_b16 v[210:211], v16 offset:30528
    v_mfma_f32_16x16x32_bf16 v[168:171], v[240:243], v[68:71], v[168:171]
    ds_read_b64_tr_b16 v[212:213], v16 offset:28768
    ds_read_b64_tr_b16 v[214:215], v16 offset:30560
    s_waitcnt lgkmcnt(8)
    v_mfma_f32_16x16x32_bf16 v[172:175], v[244:247], v[68:71], v[172:175]
    ds_read_b64_tr_b16 v[216:217], v16 offset:28800
    ds_read_b64_tr_b16 v[218:219], v16 offset:30592
    v_mfma_f32_16x16x32_bf16 v[176:179], v[248:251], v[68:71], v[176:179]
    ds_read_b64_tr_b16 v[220:221], v16 offset:28832
    ds_read_b64_tr_b16 v[222:223], v16 offset:30624
    v_mfma_f32_16x16x32_bf16 v[180:183], v[252:255], v[68:71], v[180:183]
    ds_read_b64_tr_b16 v[224:225], v16 offset:28864
    ds_read_b64_tr_b16 v[226:227], v16 offset:30656
    s_waitcnt lgkmcnt(10)
    v_mfma_f32_16x16x32_bf16 v[156:159], v[200:203], v[72:75], v[156:159]
    ds_read_b64_tr_b16 v[228:229], v16 offset:35840
    ds_read_b64_tr_b16 v[230:231], v16 offset:37632
    v_mfma_f32_16x16x32_bf16 v[160:163], v[204:207], v[72:75], v[160:163]
    ds_read_b64_tr_b16 v[232:233], v16 offset:35872
    ds_read_b64_tr_b16 v[234:235], v16 offset:37664
    s_waitcnt lgkmcnt(10)
    v_mfma_f32_16x16x32_bf16 v[164:167], v[208:211], v[72:75], v[164:167]
    ds_read_b64_tr_b16 v[236:237], v16 offset:35904
    ds_read_b64_tr_b16 v[238:239], v16 offset:37696
    v_mfma_f32_16x16x32_bf16 v[168:171], v[212:215], v[72:75], v[168:171]
    ds_read_b64_tr_b16 v[240:241], v16 offset:35936
    ds_read_b64_tr_b16 v[242:243], v16 offset:37728
    s_waitcnt lgkmcnt(8)
    v_mfma_f32_16x16x32_bf16 v[172:175], v[216:219], v[72:75], v[172:175]
    ds_read_b64_tr_b16 v[244:245], v16 offset:35968
    ds_read_b64_tr_b16 v[246:247], v16 offset:37760
    v_mfma_f32_16x16x32_bf16 v[176:179], v[220:223], v[72:75], v[176:179]
    ds_read_b64_tr_b16 v[248:249], v16 offset:36000
    ds_read_b64_tr_b16 v[250:251], v16 offset:37792
    v_mfma_f32_16x16x32_bf16 v[180:183], v[224:227], v[72:75], v[180:183]
    ds_read_b64_tr_b16 v[252:253], v16 offset:36032
    ds_read_b64_tr_b16 v[254:255], v16 offset:37824
    s_waitcnt lgkmcnt(10)
    v_mfma_f32_16x16x32_bf16 v[156:159], v[228:231], v[76:79], v[156:159]
    ds_read_b64_tr_b16 v[200:201], v16 offset:43008
    ds_read_b64_tr_b16 v[202:203], v16 offset:44800
    v_mfma_f32_16x16x32_bf16 v[160:163], v[232:235], v[76:79], v[160:163]
    ds_read_b64_tr_b16 v[204:205], v16 offset:43040
    ds_read_b64_tr_b16 v[206:207], v16 offset:44832
    s_waitcnt lgkmcnt(10)
    v_mfma_f32_16x16x32_bf16 v[164:167], v[236:239], v[76:79], v[164:167]
    ds_read_b64_tr_b16 v[208:209], v16 offset:43072
    ds_read_b64_tr_b16 v[210:211], v16 offset:44864
    v_mfma_f32_16x16x32_bf16 v[168:171], v[240:243], v[76:79], v[168:171]
    ds_read_b64_tr_b16 v[212:213], v16 offset:43104
    ds_read_b64_tr_b16 v[214:215], v16 offset:44896
    s_waitcnt lgkmcnt(8)
    v_mfma_f32_16x16x32_bf16 v[172:175], v[244:247], v[76:79], v[172:175]
    ds_read_b64_tr_b16 v[216:217], v16 offset:43136
    ds_read_b64_tr_b16 v[218:219], v16 offset:44928
    v_mfma_f32_16x16x32_bf16 v[176:179], v[248:251], v[76:79], v[176:179]
    ds_read_b64_tr_b16 v[220:221], v16 offset:43168
    ds_read_b64_tr_b16 v[222:223], v16 offset:44960
    v_mfma_f32_16x16x32_bf16 v[180:183], v[252:255], v[76:79], v[180:183]
    ds_read_b64_tr_b16 v[224:225], v16 offset:43200
    ds_read_b64_tr_b16 v[226:227], v16 offset:44992
    s_waitcnt lgkmcnt(10)
    v_mfma_f32_16x16x32_bf16 v[156:159], v[200:203], v[80:83], v[156:159]
    ds_read_b64_tr_b16 v[228:229], v16 offset:50176
    ds_read_b64_tr_b16 v[230:231], v16 offset:51968
    v_mfma_f32_16x16x32_bf16 v[160:163], v[204:207], v[80:83], v[160:163]
    ds_read_b64_tr_b16 v[232:233], v16 offset:50208
    ds_read_b64_tr_b16 v[234:235], v16 offset:52000
    s_waitcnt lgkmcnt(10)
    v_mfma_f32_16x16x32_bf16 v[164:167], v[208:211], v[80:83], v[164:167]
    ds_read_b64_tr_b16 v[236:237], v16 offset:50240
    ds_read_b64_tr_b16 v[238:239], v16 offset:52032
    v_mfma_f32_16x16x32_bf16 v[168:171], v[212:215], v[80:83], v[168:171]
    ds_read_b64_tr_b16 v[240:241], v16 offset:50272
    ds_read_b64_tr_b16 v[242:243], v16 offset:52064
    s_waitcnt lgkmcnt(8)
    v_mfma_f32_16x16x32_bf16 v[172:175], v[216:219], v[80:83], v[172:175]
    ds_read_b64_tr_b16 v[244:245], v16 offset:50304
    ds_read_b64_tr_b16 v[246:247], v16 offset:52096
    v_mfma_f32_16x16x32_bf16 v[176:179], v[220:223], v[80:83], v[176:179]
    ds_read_b64_tr_b16 v[248:249], v16 offset:50336
    ds_read_b64_tr_b16 v[250:251], v16 offset:52128
    v_mfma_f32_16x16x32_bf16 v[180:183], v[224:227], v[80:83], v[180:183]
    ds_read_b64_tr_b16 v[252:253], v16 offset:50368
    ds_read_b64_tr_b16 v[254:255], v16 offset:52160
    s_barrier
    buffer_load_dwordx4 v[40:43], v20, s[8:11], s36 offen offset:0 sc1
    buffer_load_dwordx4 v[44:47], v20, s[8:11], s36 offen offset:256 sc1
    s_waitcnt lgkmcnt(10)
    v_mfma_f32_16x16x32_bf16 v[156:159], v[228:231], v[84:87], v[156:159]
    ds_read_b64_tr_b16 v[200:201], v17 offset:0
    ds_read_b64_tr_b16 v[202:203], v17 offset:1792
    v_mfma_f32_16x16x32_bf16 v[160:163], v[232:235], v[84:87], v[160:163]
    ds_read_b64_tr_b16 v[204:205], v17 offset:32
    ds_read_b64_tr_b16 v[206:207], v17 offset:1824
    s_waitcnt lgkmcnt(10)
    v_mfma_f32_16x16x32_bf16 v[164:167], v[236:239], v[84:87], v[164:167]
    ds_read_b64_tr_b16 v[208:209], v17 offset:64
    ds_read_b64_tr_b16 v[210:211], v17 offset:1856
    v_mfma_f32_16x16x32_bf16 v[168:171], v[240:243], v[84:87], v[168:171]
    ds_read_b64_tr_b16 v[212:213], v17 offset:96
    ds_read_b64_tr_b16 v[214:215], v17 offset:1888
    s_waitcnt lgkmcnt(8)
    v_mfma_f32_16x16x32_bf16 v[172:175], v[244:247], v[84:87], v[172:175]
    ds_read_b64_tr_b16 v[216:217], v17 offset:128
    ds_read_b64_tr_b16 v[218:219], v17 offset:1920
    v_mfma_f32_16x16x32_bf16 v[176:179], v[248:251], v[84:87], v[176:179]
    ds_read_b64_tr_b16 v[220:221], v17 offset:160
    ds_read_b64_tr_b16 v[222:223], v17 offset:1952
    v_mfma_f32_16x16x32_bf16 v[180:183], v[252:255], v[84:87], v[180:183]
    ds_read_b64_tr_b16 v[224:225], v17 offset:192
    ds_read_b64_tr_b16 v[226:227], v17 offset:1984
    s_waitcnt lgkmcnt(10)
    v_mfma_f32_16x16x32_bf16 v[156:159], v[200:203], v[88:91], v[156:159]
    ds_read_b64_tr_b16 v[228:229], v17 offset:7168
    ds_read_b64_tr_b16 v[230:231], v17 offset:8960
    v_mfma_f32_16x16x32_bf16 v[160:163], v[204:207], v[88:91], v[160:163]
    ds_read_b64_tr_b16 v[232:233], v17 offset:7200
    ds_read_b64_tr_b16 v[234:235], v17 offset:8992
    s_waitcnt lgkmcnt(10)
    v_mfma_f32_16x16x32_bf16 v[164:167], v[208:211], v[88:91], v[164:167]
    ds_read_b64_tr_b16 v[236:237], v17 offset:7232
    ds_read_b64_tr_b16 v[238:239], v17 offset:9024
    v_mfma_f32_16x16x32_bf16 v[168:171], v[212:215], v[88:91], v[168:171]
    ds_read_b64_tr_b16 v[240:241], v17 offset:7264
    ds_read_b64_tr_b16 v[242:243], v17 offset:9056
    s_waitcnt lgkmcnt(8)
    v_mfma_f32_16x16x32_bf16 v[172:175], v[216:219], v[88:91], v[172:175]
    ds_read_b64_tr_b16 v[244:245], v17 offset:7296
    ds_read_b64_tr_b16 v[246:247], v17 offset:9088
    v_mfma_f32_16x16x32_bf16 v[176:179], v[220:223], v[88:91], v[176:179]
    ds_read_b64_tr_b16 v[248:249], v17 offset:7328
    ds_read_b64_tr_b16 v[250:251], v17 offset:9120
    v_mfma_f32_16x16x32_bf16 v[180:183], v[224:227], v[88:91], v[180:183]
    ds_read_b64_tr_b16 v[252:253], v17 offset:7360
    ds_read_b64_tr_b16 v[254:255], v17 offset:9152
    s_waitcnt lgkmcnt(10)
    v_mfma_f32_16x16x32_bf16 v[156:159], v[228:231], v[92:95], v[156:159]
    ds_read_b64_tr_b16 v[200:201], v17 offset:14336
    ds_read_b64_tr_b16 v[202:203], v17 offset:16128
    v_mfma_f32_16x16x32_bf16 v[160:163], v[232:235], v[92:95], v[160:163]
    ds_read_b64_tr_b16 v[204:205], v17 offset:14368
    ds_read_b64_tr_b16 v[206:207], v17 offset:16160
    s_waitcnt lgkmcnt(10)
    v_mfma_f32_16x16x32_bf16 v[164:167], v[236:239], v[92:95], v[164:167]
    ds_read_b64_tr_b16 v[208:209], v17 offset:14400
    ds_read_b64_tr_b16 v[210:211], v17 offset:16192
    v_mfma_f32_16x16x32_bf16 v[168:171], v[240:243], v[92:95], v[168:171]
    ds_read_b64_tr_b16 v[212:213], v17 offset:14432
    ds_read_b64_tr_b16 v[214:215], v17 offset:16224
    s_waitcnt lgkmcnt(8)
    v_mfma_f32_16x16x32_bf16 v[172:175], v[244:247], v[92:95], v[172:175]
    ds_read_b64_tr_b16 v[216:217], v17 offset:14464
    ds_read_b64_tr_b16 v[218:219], v17 offset:16256
    v_mfma_f32_16x16x32_bf16 v[176:179], v[248:251], v[92:95], v[176:179]
    ds_read_b64_tr_b16 v[220:221], v17 offset:14496
    ds_read_b64_tr_b16 v[222:223], v17 offset:16288
    v_mfma_f32_16x16x32_bf16 v[180:183], v[252:255], v[92:95], v[180:183]
    ds_read_b64_tr_b16 v[224:225], v17 offset:14528
    ds_read_b64_tr_b16 v[226:227], v17 offset:16320
    s_waitcnt lgkmcnt(10)
    v_mfma_f32_16x16x32_bf16 v[156:159], v[200:203], v[96:99], v[156:159]
    ds_read_b64_tr_b16 v[228:229], v17 offset:21504
    ds_read_b64_tr_b16 v[230:231], v17 offset:23296
    v_mfma_f32_16x16x32_bf16 v[160:163], v[204:207], v[96:99], v[160:163]
    ds_read_b64_tr_b16 v[232:233], v17 offset:21536
    ds_read_b64_tr_b16 v[234:235], v17 offset:23328
    s_waitcnt lgkmcnt(10)
    v_mfma_f32_16x16x32_bf16 v[164:167], v[208:211], v[96:99], v[164:167]
    ds_read_b64_tr_b16 v[236:237], v17 offset:21568
    ds_read_b64_tr_b16 v[238:239], v17 offset:23360
    v_mfma_f32_16x16x32_bf16 v[168:171], v[212:215], v[96:99], v[168:171]
    ds_read_b64_tr_b16 v[240:241], v17 offset:21600
    ds_read_b64_tr_b16 v[242:243], v17 offset:23392
    s_waitcnt lgkmcnt(8)
    v_mfma_f32_16x16x32_bf16 v[172:175], v[216:219], v[96:99], v[172:175]
    ds_read_b64_tr_b16 v[244:245], v17 offset:21632
    ds_read_b64_tr_b16 v[246:247], v17 offset:23424
    v_mfma_f32_16x16x32_bf16 v[176:179], v[220:223], v[96:99], v[176:179]
    ds_read_b64_tr_b16 v[248:249], v17 offset:21664
    ds_read_b64_tr_b16 v[250:251], v17 offset:23456
    v_mfma_f32_16x16x32_bf16 v[180:183], v[224:227], v[96:99], v[180:183]
    ds_read_b64_tr_b16 v[252:253], v17 offset:21696
    ds_read_b64_tr_b16 v[254:255], v17 offset:23488
    s_waitcnt lgkmcnt(12)
    v_mfma_f32_16x16x32_bf16 v[156:159], v[228:231], v[100:103], v[156:159]
    s_waitcnt lgkmcnt(10)
    v_mfma_f32_16x16x32_bf16 v[160:163], v[232:235], v[100:103], v[160:163]
    s_waitcnt lgkmcnt(8)
    v_mfma_f32_16x16x32_bf16 v[164:167], v[236:239], v[100:103], v[164:167]
    s_waitcnt lgkmcnt(6)
    v_mfma_f32_16x16x32_bf16 v[168:171], v[240:243], v[100:103], v[168:171]
    s_waitcnt lgkmcnt(4)
    v_mfma_f32_16x16x32_bf16 v[172:175], v[244:247], v[100:103], v[172:175]
    s_waitcnt lgkmcnt(2)
    v_mfma_f32_16x16x32_bf16 v[176:179], v[248:251], v[100:103], v[176:179]
    s_waitcnt lgkmcnt(0)
    v_mfma_f32_16x16x32_bf16 v[180:183], v[252:255], v[100:103], v[180:183]
    s_barrier
    s_mov_b32 s40, 0
recurrent_scan__ssm_conv_s4d__mixer_gmlp__prompt_kernel_s1_chk:
    s_waitcnt vmcnt(0)
    v_xor_b32 v52, v45, v2
    v_xor_b32 v53, v47, v3
    v_xor_b32 v54, v41, v2
    v_xor_b32 v55, v43, v3
    v_or3_b32 v52, v52, v53, v54
    v_or_b32 v52, v52, v55
    v_cmp_ne_u32 vcc, 0, v52
    s_nop 1
    s_cbranch_vccnz recurrent_scan__ssm_conv_s4d__mixer_gmlp__prompt_kernel_s1_retry
recurrent_scan__ssm_conv_s4d__mixer_gmlp__prompt_kernel_s1_ok:
    v_add_f32 v48, v40, v44
    v_add_f32 v49, v42, v46
    v_mov_b32 v50, v48
    v_mov_b32 v51, v49
    s_nop 0
    v_permlane32_swap_b32 v48, v50
    v_permlane32_swap_b32 v49, v51
    v_add_f32 v48, v48, v50
    v_add_f32 v49, v49, v51
    v_mov_b32 v50, v48
    v_mov_b32 v51, v49
    s_nop 0
    v_permlane16_swap_b32 v48, v50
    v_permlane16_swap_b32 v49, v51
    v_add_f32 v48, v48, v50
    v_add_f32 v49, v49, v51
    v_mul_f32 v48, 0x3a924925, v48
    v_mul_f32 v50, v48, v48
    v_mul_f32 v49, 0x3a924925, v49
    v_sub_f32 v49, v49, v50
    v_max_f32_e64 v49, 0, v49
    v_cvt_pk_bf16_f32 v49, v49, v49
    v_and_b32 v49, 0xffff0000, v49
    v_cvt_pk_bf16_f32 v48, v48, v48
    v_and_b32 v48, 0xffff0000, v48
    v_add_f32 v49, 0x3727c5ac, v49
    v_cvt_pk_bf16_f32 v49, v49, v49
    v_and_b32 v49, 0xffff0000, v49
    v_sqrt_f32 v49, v49
    s_nop 0
    v_cvt_pk_bf16_f32 v49, v49, v49
    v_and_b32 v49, 0xffff0000, v49
    v_rcp_f32 v49, v49
    s_nop 0
    v_mul_f32 v48, -v48, v49
    v_fma_f32 v128, v128, v49, v48
    v_fma_f32 v129, v129, v49, v48
    v_fma_f32 v130, v130, v49, v48
    v_fma_f32 v131, v131, v49, v48
    v_cvt_pk_bf16_f32 v128, v128, v129
    v_cvt_pk_bf16_f32 v129, v130, v131
    ds_write_b64 v21, v[128:129] offset:0
    v_fma_f32 v132, v132, v49, v48
    v_fma_f32 v133, v133, v49, v48
    v_fma_f32 v134, v134, v49, v48
    v_fma_f32 v135, v135, v49, v48
    v_cvt_pk_bf16_f32 v132, v132, v133
    v_cvt_pk_bf16_f32 v133, v134, v135
    ds_write_b64 v21, v[132:133] offset:32
    ds_read_b64_tr_b16 v[184:185], v22 offset:0
    ds_read_b64_tr_b16 v[186:187], v22 offset:928
    v_fma_f32 v136, v136, v49, v48
    v_fma_f32 v137, v137, v49, v48
    v_fma_f32 v138, v138, v49, v48
    v_fma_f32 v139, v139, v49, v48
    v_cvt_pk_bf16_f32 v136, v136, v137
    v_cvt_pk_bf16_f32 v137, v138, v139
    ds_write_b64 v21, v[136:137] offset:64
    v_fma_f32 v140, v140, v49, v48
    v_fma_f32 v141, v141, v49, v48
    v_fma_f32 v142, v142, v49, v48
    v_fma_f32 v143, v143, v49, v48
    v_cvt_pk_bf16_f32 v140, v140, v141
    v_cvt_pk_bf16_f32 v141, v142, v143
    ds_write_b64 v21, v[140:141] offset:96
    ds_read_b64_tr_b16 v[188:189], v22 offset:64
    ds_read_b64_tr_b16 v[190:191], v22 offset:992
    s_waitcnt lgkmcnt(4)
    buffer_store_dwordx4 v[184:187], v23, s[8:11], s56 offen sc1
    s_add_u32 s56, s56, 133120
    v_fma_f32 v144, v144, v49, v48
    v_fma_f32 v145, v145, v49, v48
    v_fma_f32 v146, v146, v49, v48
    v_fma_f32 v147, v147, v49, v48
    v_cvt_pk_bf16_f32 v144, v144, v145
    v_cvt_pk_bf16_f32 v145, v146, v147
    ds_write_b64 v21, v[144:145] offset:128
    v_fma_f32 v148, v148, v49, v48
    v_fma_f32 v149, v149, v49, v48
    v_fma_f32 v150, v150, v49, v48
    v_fma_f32 v151, v151, v49, v48
    v_cvt_pk_bf16_f32 v148, v148, v149
    v_cvt_pk_bf16_f32 v149, v150, v151
    ds_write_b64 v21, v[148:149] offset:160
    ds_read_b64_tr_b16 v[192:193], v22 offset:128
    ds_read_b64_tr_b16 v[194:195], v22 offset:1056
    s_waitcnt lgkmcnt(4)
    buffer_store_dwordx4 v[188:191], v23, s[8:11], s56 offen sc1
    s_add_u32 s56, s56, 133120
    v_fma_f32 v152, v152, v49, v48
    v_fma_f32 v153, v153, v49, v48
    v_fma_f32 v154, v154, v49, v48
    v_fma_f32 v155, v155, v49, v48
    v_cvt_pk_bf16_f32 v152, v152, v153
    v_cvt_pk_bf16_f32 v153, v154, v155
    ds_write_b64 v21, v[152:153] offset:192
    ds_read_b64_tr_b16 v[196:197], v22 offset:192
    ds_read_b64_tr_b16 v[198:199], v22 offset:1120
    s_waitcnt lgkmcnt(3)
    buffer_store_dwordx4 v[192:195], v23, s[8:11], s56 offen sc1
    s_add_u32 s56, s56, 133120
    ds_read_b64_tr_b16 v[200:201], v17 offset:28672
    ds_read_b64_tr_b16 v[202:203], v17 offset:30464
    ds_read_b64_tr_b16 v[204:205], v17 offset:28704
    ds_read_b64_tr_b16 v[206:207], v17 offset:30496
    ds_read_b64_tr_b16 v[208:209], v17 offset:28736
    ds_read_b64_tr_b16 v[210:211], v17 offset:30528
    ds_read_b64_tr_b16 v[212:213], v17 offset:28768
    ds_read_b64_tr_b16 v[214:215], v17 offset:30560
    ds_read_b64_tr_b16 v[216:217], v17 offset:28800
    ds_read_b64_tr_b16 v[218:219], v17 offset:30592
    ds_read_b64_tr_b16 v[220:221], v17 offset:28832
    ds_read_b64_tr_b16 v[222:223], v17 offset:30624
    ds_read_b64_tr_b16 v[224:225], v17 offset:28864
    ds_read_b64_tr_b16 v[226:227], v17 offset:30656
    s_mov_b32 exec_hi, 0
    s_waitcnt lgkmcnt(14)
    buffer_store_dwordx4 v[196:199], v23, s[8:11], s56 offen sc1
    s_mov_b32 exec_hi, -1
    s_add_u32 s7, s64, s35
    s_xor_b32 s7, s7, 384
    s_add_u32 m0, s62, 0
    s_nop 0
    buffer_load_dwordx4 v120, s[20:23], s7 offen offset:0 lds
    buffer_load_dwordx4 v121, s[20:23], s7 offen offset:1024 lds
    buffer_load_dwordx4 v122, s[20:23], s7 offen offset:2048 lds
    buffer_load_dwordx4 v123, s[20:23], s7 offen offset:3072 lds
    s_waitcnt lgkmcnt(10)
    v_mfma_f32_16x16x32_bf16 v[156:159], v[200:203], v[104:107], v[156:159]
    ds_read_b64_tr_b16 v[228:229], v17 offset:35840
    ds_read_b64_tr_b16 v[230:231], v17 offset:37632
    v_mfma_f32_16x16x32_bf16 v[160:163], v[204:207], v[104:107], v[160:163]
    ds_read_b64_tr_b16 v[232:233], v17 offset:35872
    ds_read_b64_tr_b16 v[234:235], v17 offset:37664
    s_waitcnt lgkmcnt(10)
    v_mfma_f32_16x16x32_bf16 v[164:167], v[208:211], v[104:107], v[164:167]
    ds_read_b64_tr_b16 v[236:237], v17 offset:35904
    ds_read_b64_tr_b16 v[238:239], v17 offset:37696
    v_mfma_f32_16x16x32_bf16 v[168:171], v[212:215], v[104:107], v[168:171]
    ds_read_b64_tr_b16 v[240:241], v17 offset:35936
    ds_read_b64_tr_b16 v[242:243], v17 offset:37728
    s_waitcnt lgkmcnt(8)
    v_mfma_f32_16x16x32_bf16 v[172:175], v[216:219], v[104:107], v[172:175]
    ds_read_b64_tr_b16 v[244:245], v17 offset:35968
    ds_read_b64_tr_b16 v[246:247], v17 offset:37760
    v_mfma_f32_16x16x32_bf16 v[176:179], v[220:223], v[104:107], v[176:179]
    ds_read_b64_tr_b16 v[248:249], v17 offset:36000
    ds_read_b64_tr_b16 v[250:251], v17 offset:37792
    v_mfma_f32_16x16x32_bf16 v[180:183], v[224:227], v[104:107], v[180:183]
    ds_read_b64_tr_b16 v[252:253], v17 offset:36032
    ds_read_b64_tr_b16 v[254:255], v17 offset:37824
    s_waitcnt lgkmcnt(10)
    v_mfma_f32_16x16x32_bf16 v[156:159], v[228:231], v[108:111], v[156:159]
    ds_read_b64_tr_b16 v[200:201], v17 offset:43008
    ds_read_b64_tr_b16 v[202:203], v17 offset:44800
    v_mfma_f32_16x16x32_bf16 v[160:163], v[232:235], v[108:111], v[160:163]
    ds_read_b64_tr_b16 v[204:205], v17 offset:43040
    ds_read_b64_tr_b16 v[206:207], v17 offset:44832
    s_waitcnt lgkmcnt(10)
    v_mfma_f32_16x16x32_bf16 v[164:167], v[236:239], v[108:111], v[164:167]
    ds_read_b64_tr_b16 v[208:209], v17 offset:43072
    ds_read_b64_tr_b16 v[210:211], v17 offset:44864
    v_mfma_f32_16x16x32_bf16 v[168:171], v[240:243], v[108:111], v[168:171]
    ds_read_b64_tr_b16 v[212:213], v17 offset:43104
    ds_read_b64_tr_b16 v[214:215], v17 offset:44896
    s_waitcnt lgkmcnt(8)
    v_mfma_f32_16x16x32_bf16 v[172:175], v[244:247], v[108:111], v[172:175]
    ds_read_b64_tr_b16 v[216:217], v17 offset:43136
    ds_read_b64_tr_b16 v[218:219], v17 offset:44928
    v_mfma_f32_16x16x32_bf16 v[176:179], v[248:251], v[108:111], v[176:179]
    ds_read_b64_tr_b16 v[220:221], v17 offset:43168
    ds_read_b64_tr_b16 v[222:223], v17 offset:44960
    v_mfma_f32_16x16x32_bf16 v[180:183], v[252:255], v[108:111], v[180:183]
    ds_read_b64_tr_b16 v[224:225], v17 offset:43200
    ds_read_b64_tr_b16 v[226:227], v17 offset:44992
    s_add_u32 m0, s62, 4096
    s_xor_b32 s7, s7, 0x20000
    buffer_load_dwordx4 v120, s[20:23], s7 offen offset:0 lds
    buffer_load_dwordx4 v121, s[20:23], s7 offen offset:1024 lds
    buffer_load_dwordx4 v122, s[20:23], s7 offen offset:2048 lds
    buffer_load_dwordx4 v123, s[20:23], s7 offen offset:3072 lds
    s_waitcnt lgkmcnt(10)
    v_mfma_f32_16x16x32_bf16 v[156:159], v[200:203], v[112:115], v[156:159]
    ds_read_b64_tr_b16 v[228:229], v17 offset:50176
    ds_read_b64_tr_b16 v[230:231], v17 offset:51968
    v_mfma_f32_16x16x32_bf16 v[160:163], v[204:207], v[112:115], v[160:163]
    ds_read_b64_tr_b16 v[232:233], v17 offset:50208
    ds_read_b64_tr_b16 v[234:235], v17 offset:52000
    s_waitcnt lgkmcnt(10)
    v_mfma_f32_16x16x32_bf16 v[164:167], v[208:211], v[112:115], v[164:167]
    ds_read_b64_tr_b16 v[236:237], v17 offset:50240
    ds_read_b64_tr_b16 v[238:239], v17 offset:52032
    v_mfma_f32_16x16x32_bf16 v[168:171], v[212:215], v[112:115], v[168:171]
    ds_read_b64_tr_b16 v[240:241], v17 offset:50272
    ds_read_b64_tr_b16 v[242:243], v17 offset:52064
    s_waitcnt lgkmcnt(8)
    v_mfma_f32_16x16x32_bf16 v[172:175], v[216:219], v[112:115], v[172:175]
    ds_read_b64_tr_b16 v[244:245], v17 offset:50304
    ds_read_b64_tr_b16 v[246:247], v17 offset:52096
    v_mfma_f32_16x16x32_bf16 v[176:179], v[220:223], v[112:115], v[176:179]
    ds_read_b64_tr_b16 v[248:249], v17 offset:50336
    ds_read_b64_tr_b16 v[250:251], v17 offset:52128
    v_mfma_f32_16x16x32_bf16 v[180:183], v[224:227], v[112:115], v[180:183]
    ds_read_b64_tr_b16 v[252:253], v17 offset:50368
    ds_read_b64_tr_b16 v[254:255], v17 offset:52160
    s_waitcnt lgkmcnt(12)
    v_mfma_f32_16x16x32_bf16 v[156:159], v[228:231], v[116:119], v[156:159]
    s_waitcnt lgkmcnt(10)
    v_mfma_f32_16x16x32_bf16 v[160:163], v[232:235], v[116:119], v[160:163]
    s_waitcnt lgkmcnt(8)
    v_mfma_f32_16x16x32_bf16 v[164:167], v[236:239], v[116:119], v[164:167]
    s_waitcnt lgkmcnt(6)
    v_mfma_f32_16x16x32_bf16 v[168:171], v[240:243], v[116:119], v[168:171]
    s_waitcnt lgkmcnt(4)
    v_mfma_f32_16x16x32_bf16 v[172:175], v[244:247], v[116:119], v[172:175]
    s_waitcnt lgkmcnt(2)
    v_mfma_f32_16x16x32_bf16 v[176:179], v[248:251], v[116:119], v[176:179]
    s_waitcnt lgkmcnt(0)
    v_mfma_f32_16x16x32_bf16 v[180:183], v[252:255], v[116:119], v[180:183]
    s_barrier
    s_add_u32 s7, s64, s35
    s_xor_b32 s7, s7, 256
    s_add_u32 m0, s63, 0
    s_nop 0
    buffer_load_dwordx4 v120, s[20:23], s7 offen offset:0 lds
    buffer_load_dwordx4 v121, s[20:23], s7 offen offset:1024 lds
    buffer_load_dwordx4 v122, s[20:23], s7 offen offset:2048 lds
    buffer_load_dwordx4 v123, s[20:23], s7 offen offset:3072 lds
    v_mov_b32 v44, v24
    v_mov_b32 v45, v25
    v_mov_b32 v46, v38
    v_mov_b32_e64 v47, v39
    v_cvt_pk_bf16_f32 v12, v156, v157
    v_cvt_pk_bf16_f32 v13, v158, v159
    v_cvt_pk_bf16_f32 v14, v160, v161
    v_cvt_pk_bf16_f32 v15, v162, v163
    v_cvt_pk_bf16_f32 v16, v164, v165
    v_cvt_pk_bf16_f32 v17, v166, v167
    v_cvt_pk_bf16_f32 v18, v168, v169
    v_cvt_pk_bf16_f32 v19, v170, v171
    v_cvt_pk_bf16_f32 v20, v172, v173
    v_cvt_pk_bf16_f32 v21, v174, v175
    v_cvt_pk_bf16_f32 v22, v176, v177
    v_cvt_pk_bf16_f32 v23, v178, v179
    v_cvt_pk_bf16_f32 v24, v180, v181
    v_cvt_pk_bf16_f32 v25, v182, v183
    s_waitcnt vmcnt(12)
    s_barrier
    s_add_u32 m0, s63, 4096
    s_xor_b32 s7, s7, 0x20000
    buffer_load_dwordx4 v120, s[20:23], s7 offen offset:0 lds
    buffer_load_dwordx4 v121, s[20:23], s7 offen offset:1024 lds
    buffer_load_dwordx4 v122, s[20:23], s7 offen offset:2048 lds
    buffer_load_dwordx4 v123, s[20:23], s7 offen offset:3072 lds
    s_mul_i32 s50, s51, 33792
    s_add_u32 s50, s50, 4194304
    s_lshl_b32 s54, s51, 14
    s_lshl_b32 s7, s4, 7
    s_add_u32 s54, s54, s7
    s_lshl2_add_u32 s55, s59, s58
    s_lshl_b32 s55, s55, 11
    s_add_u32 s55, s55, 4096
    s_mov_b32 s61, 0xffff0000
    s_mul_i32 s7, s4, 465920
    s_lshl_b32 s32, s49, 13
    s_add_u32 s42, s7, s32
    s_add_u32 s43, s42, 66560
    s_add_u32 s44, s42, 133120
    s_add_u32 s45, s42, 199680
    s_add_u32 s46, s42, 266240
    s_add_u32 s47, s42, 332800
    s_add_u32 s48, s42, 399360
    s_lshl_b32 s32, s4, 12
    s_add_u32 s37, s50, s32
    s_waitcnt vmcnt(8)
    ds_read_b128 v[224:227], v124 offset:0
    ds_read_b128 v[228:231], v124 offset:2048
    ds_read_b128 v[232:235], v124 offset:4096
    ds_read_b128 v[236:239], v124 offset:6144
    ds_read_b128 v[240:243], v125 offset:0
    ds_read_b128 v[244:247], v125 offset:2048
    ds_read_b128 v[248:251], v125 offset:4096
    ds_read_b128 v[252:255], v125 offset:6144
    s_barrier
    s_add_u32 s7, s65, s64
    s_xor_b32 s7, s7, 768
    s_add_u32 m0, s62, 4294918144
    s_nop 0
    buffer_load_dwordx4 v120, s[20:23], s7 offen offset:0 lds
    buffer_load_dwordx4 v121, s[20:23], s7 offen offset:1024 lds
    buffer_load_dwordx4 v122, s[20:23], s7 offen offset:2048 lds
    buffer_load_dwordx4 v123, s[20:23], s7 offen offset:3072 lds
    s_add_u32 m0, s62, 4294922240
    s_xor_b32 s7, s7, 0x20000
    buffer_load_dwordx4 v120, s[20:23], s7 offen offset:0 lds
    buffer_load_dwordx4 v121, s[20:23], s7 offen offset:1024 lds
    buffer_load_dwordx4 v122, s[20:23], s7 offen offset:2048 lds
    buffer_load_dwordx4 v123, s[20:23], s7 offen offset:3072 lds
    s_waitcnt lgkmcnt(0)
    s_add_u32 s7, s64, s35
    s_xor_b32 s7, s7, 0
    s_add_u32 m0, s62, 0
    s_nop 0
    buffer_load_dwordx4 v120, s[20:23], s7 offen offset:0 lds
    buffer_load_dwordx4 v121, s[20:23], s7 offen offset:1024 lds
    buffer_load_dwordx4 v122, s[20:23], s7 offen offset:2048 lds
    buffer_load_dwordx4 v123, s[20:23], s7 offen offset:3072 lds
    s_add_u32 m0, s62, 4096
    s_xor_b32 s7, s7, 0x20000
    buffer_load_dwordx4 v120, s[20:23], s7 offen offset:0 lds
    buffer_load_dwordx4 v121, s[20:23], s7 offen offset:1024 lds
    buffer_load_dwordx4 v122, s[20:23], s7 offen offset:2048 lds
    buffer_load_dwordx4 v123, s[20:23], s7 offen offset:3072 lds
    s_waitcnt vmcnt(16)
    ds_read_b128 v[192:195], v126 offset:0
    ds_read_b128 v[196:199], v126 offset:2048
    ds_read_b128 v[200:203], v126 offset:4096
    ds_read_b128 v[204:207], v126 offset:6144
    ds_read_b128 v[208:211], v127 offset:0
    ds_read_b128 v[212:215], v127 offset:2048
    ds_read_b128 v[216:219], v127 offset:4096
    ds_read_b128 v[220:223], v127 offset:6144
    s_add_u32 s7, s65, s64
    s_xor_b32 s7, s7, 896
    s_add_u32 m0, s62, 65536
    s_nop 0
    buffer_load_dwordx4 v120, s[20:23], s7 offen offset:0 lds
    buffer_load_dwordx4 v121, s[20:23], s7 offen offset:1024 lds
    buffer_load_dwordx4 v122, s[20:23], s7 offen offset:2048 lds
    buffer_load_dwordx4 v123, s[20:23], s7 offen offset:3072 lds
    s_add_u32 m0, s62, 69632
    s_xor_b32 s7, s7, 0x20000
    buffer_load_dwordx4 v120, s[20:23], s7 offen offset:0 lds
    buffer_load_dwordx4 v121, s[20:23], s7 offen offset:1024 lds
    buffer_load_dwordx4 v122, s[20:23], s7 offen offset:2048 lds
    buffer_load_dwordx4 v123, s[20:23], s7 offen offset:3072 lds
    s_lshl2_add_u32 s41, s4, s3
    s_lshl_b32 s41, s41, 10
    s_add_u32 s41, s41, 17498112
    buffer_load_dwordx2 v[36:37], v35, s[8:11], s41 offen sc1
    s_waitcnt lgkmcnt(0)
    s_add_u32 s7, s64, s35
    s_xor_b32 s7, s7, 128
    s_add_u32 m0, s63, 0
    s_nop 0
    buffer_load_dwordx4 v120, s[20:23], s7 offen offset:0 lds
    buffer_load_dwordx4 v121, s[20:23], s7 offen offset:1024 lds
    buffer_load_dwordx4 v122, s[20:23], s7 offen offset:2048 lds
    buffer_load_dwordx4 v123, s[20:23], s7 offen offset:3072 lds
    s_add_u32 m0, s63, 4096
    s_xor_b32 s7, s7, 0x20000
    buffer_load_dwordx4 v120, s[20:23], s7 offen offset:0 lds
    buffer_load_dwordx4 v121, s[20:23], s7 offen offset:1024 lds
    buffer_load_dwordx4 v122, s[20:23], s7 offen offset:2048 lds
    buffer_load_dwordx4 v123, s[20:23], s7 offen offset:3072 lds
    v_or_b32 v40, s2, v0
    v_or_b32 v40, s3, v40
    v_lshlrev_b32 v40, 17, v40
    s_mov_b32 s7, 17760256
    s_lshl3_add_u32 s56, s51, s4
    s_lshl_b32 s56, s56, 7
    s_add_u32 s56, s56, 17235968
    s_waitcnt vmcnt(17)
    ds_read_b128 v[128:131], v124 offset:0
    ds_read_b128 v[132:135], v124 offset:2048
    ds_read_b128 v[136:139], v124 offset:4096
    ds_read_b128 v[140:143], v124 offset:6144
    ds_read_b128 v[144:147], v125 offset:0
    ds_read_b128 v[148:151], v125 offset:2048
    ds_read_b128 v[152:155], v125 offset:4096
    ds_read_b128 v[156:159], v125 offset:6144
    s_mov_b32 s40, 0
recurrent_scan__ssm_conv_s4d__mixer_gmlp__prompt_kernel_s2G_chk:
    s_waitcnt vmcnt(8)
    v_cmp_ne_u64 vcc, v[36:37], v[2:3]
    s_nop 1
    s_cbranch_vccnz recurrent_scan__ssm_conv_s4d__mixer_gmlp__prompt_kernel_s2G_retry
recurrent_scan__ssm_conv_s4d__mixer_gmlp__prompt_kernel_s2G_ok:
    s_waitcnt lgkmcnt(0)
    s_barrier
    s_setprio 0
    buffer_load_dwordx4 v[56:59], v26, s[8:11], s42 offen offset:0 sc1
    buffer_load_dwordx4 v[60:63], v26, s[8:11], s42 offen offset:1024 sc1
    buffer_load_dwordx4 v[64:67], v27, s[8:11], s42 offen offset:0 sc1
    buffer_load_dwordx4 v[68:71], v27, s[8:11], s42 offen offset:1024 sc1
    buffer_load_dwordx4 v[72:75], v28, s[8:11], s42 offen offset:0 sc1
    buffer_load_dwordx4 v[76:79], v28, s[8:11], s42 offen offset:1024 sc1
    buffer_load_dwordx4 v[80:83], v29, s[8:11], s42 offen offset:0 sc1
    buffer_load_dwordx4 v[84:87], v29, s[8:11], s42 offen offset:1024 sc1
    s_waitcnt vmcnt(8)
    ds_read_b128 v[160:163], v126 offset:0
    ds_read_b128 v[164:167], v126 offset:2048
    ds_read_b128 v[168:171], v126 offset:4096
    ds_read_b128 v[172:175], v126 offset:6144
    ds_read_b128 v[176:179], v127 offset:0
    ds_read_b128 v[180:183], v127 offset:2048
    ds_read_b128 v[184:187], v127 offset:4096
    ds_read_b128 v[188:191], v127 offset:6144
    s_lshl_b32 s41, s51, 10
    s_add_u32 s41, s41, 17235968
    v_and_b32 v35, 0x180, v35
    buffer_store_dword v2, v40, s[8:11], s7 offen
    s_waitcnt vmcnt(8)
    v_mfma_f32_16x16x32_bf16 v[88:91], v[56:59], v[128:131], v[4:7]
    v_mfma_f32_16x16x32_bf16 v[92:95], v[56:59], v[132:135], 0
    v_mfma_f32_16x16x32_bf16 v[96:99], v[56:59], v[136:139], 0
    v_mfma_f32_16x16x32_bf16 v[100:103], v[56:59], v[140:143], 0
    buffer_load_dwordx4 v[56:59], v26, s[8:11], s43 offen offset:0 sc1
    s_waitcnt vmcnt(8)
    v_mfma_f32_16x16x32_bf16 v[88:91], v[60:63], v[144:147], v[88:91]
    v_mfma_f32_16x16x32_bf16 v[92:95], v[60:63], v[148:151], v[92:95]
    v_mfma_f32_16x16x32_bf16 v[96:99], v[60:63], v[152:155], v[96:99]
    v_mfma_f32_16x16x32_bf16 v[100:103], v[60:63], v[156:159], v[100:103]
    buffer_load_dwordx4 v[60:63], v26, s[8:11], s43 offen offset:1024 sc1
    v_mov_b32 v38, s38
    v_lshlrev_b32 v120, 16, v12
    s_waitcnt vmcnt(8) lgkmcnt(7)
    v_mfma_f32_16x16x32_bf16 v[88:91], v[64:67], v[160:163], v[88:91]
    v_and_b32 v121, s61, v12
    s_waitcnt lgkmcnt(6)
    v_mfma_f32_16x16x32_bf16 v[92:95], v[64:67], v[164:167], v[92:95]
    v_lshlrev_b32 v122, 16, v13
    v_and_b32 v123, s61, v13
    s_waitcnt lgkmcnt(5)
    v_mfma_f32_16x16x32_bf16 v[96:99], v[64:67], v[168:171], v[96:99]
    v_mul_f32 v124, v120, v120
    s_waitcnt lgkmcnt(4)
    v_mfma_f32_16x16x32_bf16 v[100:103], v[64:67], v[172:175], v[100:103]
    buffer_load_dwordx4 v[64:67], v27, s[8:11], s43 offen offset:0 sc1
    v_mul_f32 v125, v121, v121
    v_mul_f32 v126, v122, v122
    s_waitcnt vmcnt(8) lgkmcnt(3)
    v_mfma_f32_16x16x32_bf16 v[88:91], v[68:71], v[176:179], v[88:91]
    v_mul_f32 v127, v123, v123
    s_waitcnt lgkmcnt(2)
    v_mfma_f32_16x16x32_bf16 v[92:95], v[68:71], v[180:183], v[92:95]
    v_fma_f32 v124, v124, s39, v38
    v_fma_f32 v125, v125, s39, v38
    s_waitcnt lgkmcnt(1)
    v_mfma_f32_16x16x32_bf16 v[96:99], v[68:71], v[184:187], v[96:99]
    v_fma_f32 v126, v126, s39, v38
    s_waitcnt lgkmcnt(0)
    v_mfma_f32_16x16x32_bf16 v[100:103], v[68:71], v[188:191], v[100:103]
    buffer_load_dwordx4 v[68:71], v27, s[8:11], s43 offen offset:1024 sc1
    v_fma_f32 v127, v127, s39, v38
    v_mul_f32 v124, v124, v120
    s_waitcnt vmcnt(8)
    v_mfma_f32_16x16x32_bf16 v[88:91], v[72:75], v[192:195], v[88:91]
    v_mul_f32 v125, v125, v121
    v_mfma_f32_16x16x32_bf16 v[92:95], v[72:75], v[196:199], v[92:95]
    v_mul_f32 v126, v126, v122
    v_mul_f32_e64 v127, v127, v123
    v_mfma_f32_16x16x32_bf16 v[96:99], v[72:75], v[200:203], v[96:99]
    v_exp_f32 v124, v124
    v_mfma_f32_16x16x32_bf16 v[100:103], v[72:75], v[204:207], v[100:103]
    buffer_load_dwordx4 v[72:75], v28, s[8:11], s43 offen offset:0 sc1
    v_exp_f32 v125, v125
    s_waitcnt vmcnt(8)
    v_mfma_f32_16x16x32_bf16 v[88:91], v[76:79], v[208:211], v[88:91]
    v_exp_f32 v126, v126
    v_exp_f32 v127, v127
    v_mfma_f32_16x16x32_bf16 v[92:95], v[76:79], v[212:215], v[92:95]
    v_add_f32 v124, 1.0, v124
    v_add_f32 v125, 1.0, v125
    v_mfma_f32_16x16x32_bf16 v[96:99], v[76:79], v[216:219], v[96:99]
    v_add_f32 v126, 1.0, v126
    v_mfma_f32_16x16x32_bf16 v[100:103], v[76:79], v[220:223], v[100:103]
    buffer_load_dwordx4 v[76:79], v28, s[8:11], s43 offen offset:1024 sc1
    v_add_f32 v127, 1.0, v127
    s_waitcnt vmcnt(8)
    v_mfma_f32_16x16x32_bf16 v[88:91], v[80:83], v[224:227], v[88:91]
    v_rcp_f32 v124, v124
    v_rcp_f32 v125, v125
    v_mfma_f32_16x16x32_bf16 v[92:95], v[80:83], v[228:231], v[92:95]
    v_rcp_f32 v126, v126
    v_rcp_f32 v127, v127
    v_mfma_f32_16x16x32_bf16 v[96:99], v[80:83], v[232:235], v[96:99]
    v_mul_f32 v120, v124, v120
    v_mfma_f32_16x16x32_bf16 v[100:103], v[80:83], v[236:239], v[100:103]
    buffer_load_dwordx4 v[80:83], v29, s[8:11], s43 offen offset:0 sc1
    v_mul_f32 v121, v125, v121
    v_mul_f32 v122, v126, v122
    s_waitcnt vmcnt(8)
    v_mfma_f32_16x16x32_bf16 v[88:91], v[84:87], v[240:243], v[88:91]
    v_mul_f32_e64 v123, v127, v123
    v_mfma_f32_16x16x32_bf16 v[92:95], v[84:87], v[244:247], v[92:95]
    v_mfma_f32_16x16x32_bf16 v[96:99], v[84:87], v[248:251], v[96:99]
    v_mfma_f32_16x16x32_bf16 v[100:103], v[84:87], v[252:255], v[100:103]
    buffer_load_dwordx4 v[84:87], v29, s[8:11], s43 offen offset:1024 sc1
    s_waitcnt vmcnt(7)
    v_mfma_f32_16x16x32_bf16 v[104:107], v[56:59], v[128:131], v[4:7]
    v_mfma_f32_16x16x32_bf16 v[108:111], v[56:59], v[132:135], 0
    v_mfma_f32_16x16x32_bf16 v[112:115], v[56:59], v[136:139], 0
    s_nop 0
    ds_write_b128 v30, v[92:95] offset:0
    v_mfma_f32_16x16x32_bf16 v[116:119], v[56:59], v[140:143], 0
    buffer_load_dwordx4 v[56:59], v26, s[8:11], s44 offen offset:0 sc1
    ds_write_b128 v31, v[96:99] offset:0
    s_waitcnt vmcnt(7)
    v_mfma_f32_16x16x32_bf16 v[104:107], v[60:63], v[144:147], v[104:107]
    ds_write_b128 v32, v[100:103] offset:0
    v_mfma_f32_16x16x32_bf16 v[108:111], v[60:63], v[148:151], v[108:111]
    v_mfma_f32_16x16x32_bf16 v[112:115], v[60:63], v[152:155], v[112:115]
    v_mfma_f32_16x16x32_bf16 v[116:119], v[60:63], v[156:159], v[116:119]
    buffer_load_dwordx4 v[60:63], v26, s[8:11], s44 offen offset:1024 sc1
    s_waitcnt vmcnt(7)
    v_mfma_f32_16x16x32_bf16 v[104:107], v[64:67], v[160:163], v[104:107]
    v_mfma_f32_16x16x32_bf16 v[108:111], v[64:67], v[164:167], v[108:111]
    s_waitcnt lgkmcnt(0)
    s_barrier
    v_add_u32 v30, 53248, v30
    v_add_u32 v31, 53248, v31
    v_add_u32 v32, 53248, v32
    v_mfma_f32_16x16x32_bf16 v[112:115], v[64:67], v[168:171], v[112:115]
    v_add_u32 v39, s55, v1
    ds_write_b128 v39, v[8:11]
    ds_write_b128 v39, v[44:47] offset:1024
    v_mfma_f32_16x16x32_bf16 v[116:119], v[64:67], v[172:175], v[116:119]
    buffer_load_dwordx4 v[64:67], v27, s[8:11], s44 offen offset:0 sc1
    ds_read_b128 v[40:43], v33 offset:0
    s_waitcnt vmcnt(7)
    v_mfma_f32_16x16x32_bf16 v[104:107], v[68:71], v[176:179], v[104:107]
    ds_read_b128 v[44:47], v33 offset:1024
    ds_read_b128 v[48:51], v33 offset:2048
    ds_read_b128 v[52:55], v33 offset:3072
    v_mfma_f32_16x16x32_bf16 v[108:111], v[68:71], v[180:183], v[108:111]
    ds_read_b128 v[92:95], v33 offset:4096
    ds_read_b128 v[96:99], v33 offset:5120
    ds_read_b128 v[100:103], v33 offset:6144
    v_mfma_f32_16x16x32_bf16 v[112:115], v[68:71], v[184:187], v[112:115]
    s_waitcnt lgkmcnt(3)
    v_add_f32 v88, v88, v40
    v_add_f32 v89, v89, v41
    v_add_f32 v90, v90, v42
    v_add_f32 v91, v91, v43
    v_mfma_f32_16x16x32_bf16 v[116:119], v[68:71], v[188:191], v[116:119]
    buffer_load_dwordx4 v[68:71], v27, s[8:11], s44 offen offset:1024 sc1
    v_add_f32 v88, v88, v44
    v_add_f32 v89, v89, v45
    s_waitcnt vmcnt(7)
    v_mfma_f32_16x16x32_bf16 v[104:107], v[72:75], v[192:195], v[104:107]
    v_add_f32 v90, v90, v46
    v_add_f32 v91, v91, v47
    v_add_f32 v88, v88, v48
    v_add_f32 v89, v89, v49
    v_add_f32 v90, v90, v50
    v_mfma_f32_16x16x32_bf16 v[108:111], v[72:75], v[196:199], v[108:111]
    v_add_f32 v91, v91, v51
    v_add_f32 v88, v88, v52
    v_add_f32 v89, v89, v53
    v_add_f32 v90, v90, v54
    v_add_f32 v91, v91, v55
    v_mfma_f32_16x16x32_bf16 v[112:115], v[72:75], v[200:203], v[112:115]
    s_waitcnt lgkmcnt(0)
    v_add_f32 v88, v88, v92
    v_add_f32 v89, v89, v93
    v_add_f32 v90, v90, v94
    v_add_f32 v91, v91, v95
    v_mfma_f32_16x16x32_bf16 v[116:119], v[72:75], v[204:207], v[116:119]
    buffer_load_dwordx4 v[72:75], v28, s[8:11], s44 offen offset:0 sc1
    v_add_f32 v88, v88, v96
    v_add_f32 v89, v89, v97
    s_waitcnt vmcnt(7)
    v_mfma_f32_16x16x32_bf16 v[104:107], v[76:79], v[208:211], v[104:107]
    v_add_f32 v90, v90, v98
    v_add_f32 v91, v91, v99
    v_add_f32 v88, v88, v100
    v_add_f32 v89, v89, v101
    v_add_f32 v90, v90, v102
    v_mfma_f32_16x16x32_bf16 v[108:111], v[76:79], v[212:215], v[108:111]
    v_add_f32 v91, v91, v103
    v_mul_f32 v88, v120, v88
    v_mul_f32 v89, v121, v89
    v_mul_f32 v90, v122, v90
    v_mul_f32 v91, v123, v91
    v_mfma_f32_16x16x32_bf16 v[112:115], v[76:79], v[216:219], v[112:115]
    v_cvt_pk_bf16_f32 v8, v88, v89
    v_cvt_pk_bf16_f32 v9, v90, v91
    v_lshlrev_b32 v120, 16, v14
    v_and_b32 v121, s61, v14
    v_lshlrev_b32 v122, 16, v15
    v_mfma_f32_16x16x32_bf16 v[116:119], v[76:79], v[220:223], v[116:119]
    buffer_load_dwordx4 v[76:79], v28, s[8:11], s44 offen offset:1024 sc1
    v_and_b32 v123, s61, v15
    v_mul_f32 v124, v120, v120
    s_waitcnt vmcnt(7)
    v_mfma_f32_16x16x32_bf16 v[104:107], v[80:83], v[224:227], v[104:107]
    v_mul_f32 v125, v121, v121
    v_mul_f32 v126, v122, v122
    v_mul_f32_e64 v127, v123, v123
    v_fma_f32 v124, v124, s39, v38
    v_fma_f32 v125, v125, s39, v38
    v_mfma_f32_16x16x32_bf16 v[108:111], v[80:83], v[228:231], v[108:111]
    v_fma_f32 v126, v126, s39, v38
    v_fma_f32 v127, v127, s39, v38
    v_mul_f32 v124, v124, v120
    v_mul_f32 v125, v125, v121
    v_mul_f32 v126, v126, v122
    v_mfma_f32_16x16x32_bf16 v[112:115], v[80:83], v[232:235], v[112:115]
    v_mul_f32 v127, v127, v123
    v_exp_f32 v124, v124
    v_exp_f32 v125, v125
    v_mfma_f32_16x16x32_bf16 v[116:119], v[80:83], v[236:239], v[116:119]
    buffer_load_dwordx4 v[80:83], v29, s[8:11], s44 offen offset:0 sc1
    v_exp_f32 v126, v126
    s_waitcnt vmcnt(7)
    v_mfma_f32_16x16x32_bf16 v[104:107], v[84:87], v[240:243], v[104:107]
    v_exp_f32 v127, v127
    v_add_f32 v124, 1.0, v124
    v_add_f32 v125, 1.0, v125
    v_add_f32 v126, 1.0, v126
    v_mfma_f32_16x16x32_bf16 v[108:111], v[84:87], v[244:247], v[108:111]
    v_add_f32 v127, 1.0, v127
    v_rcp_f32 v124, v124
    v_rcp_f32 v125, v125
    v_mfma_f32_16x16x32_bf16 v[112:115], v[84:87], v[248:251], v[112:115]
    v_rcp_f32 v126, v126
    v_rcp_f32 v127, v127
    v_mul_f32 v120, v124, v120
    v_mfma_f32_16x16x32_bf16 v[116:119], v[84:87], v[252:255], v[116:119]
    buffer_load_dwordx4 v[84:87], v29, s[8:11], s44 offen offset:1024 sc1
    v_mul_f32 v121, v125, v121
    v_mul_f32 v122, v126, v122
    s_waitcnt vmcnt(7)
    v_mfma_f32_16x16x32_bf16 v[88:91], v[56:59], v[128:131], v[4:7]
    v_mul_f32 v123, v127, v123
    v_add_u32 v33, 53248, v33
    v_mfma_f32_16x16x32_bf16 v[92:95], v[56:59], v[132:135], 0
    v_mfma_f32_16x16x32_bf16 v[96:99], v[56:59], v[136:139], 0
    ds_write_b128 v30, v[108:111] offset:0
    v_mfma_f32_16x16x32_bf16 v[100:103], v[56:59], v[140:143], 0
    buffer_load_dwordx4 v[56:59], v26, s[8:11], s45 offen offset:0 sc1
    ds_write_b128 v31, v[112:115] offset:0
    s_waitcnt vmcnt(7)
    v_mfma_f32_16x16x32_bf16 v[88:91], v[60:63], v[144:147], v[88:91]
    ds_write_b128 v32, v[116:119] offset:0
    v_mfma_f32_16x16x32_bf16 v[92:95], v[60:63], v[148:151], v[92:95]
    v_mfma_f32_16x16x32_bf16 v[96:99], v[60:63], v[152:155], v[96:99]
    v_mfma_f32_16x16x32_bf16 v[100:103], v[60:63], v[156:159], v[100:103]
    buffer_load_dwordx4 v[60:63], v26, s[8:11], s45 offen offset:1024 sc1
    s_waitcnt vmcnt(7)
    v_mfma_f32_16x16x32_bf16 v[88:91], v[64:67], v[160:163], v[88:91]
    v_mfma_f32_16x16x32_bf16 v[92:95], v[64:67], v[164:167], v[92:95]
    s_waitcnt lgkmcnt(0)
    s_barrier
    ds_read_b128 v[40:43], v33 offset:0
    ds_read_b128 v[44:47], v33 offset:1024
    v_mfma_f32_16x16x32_bf16 v[96:99], v[64:67], v[168:171], v[96:99]
    ds_read_b128 v[48:51], v33 offset:2048
    ds_read_b128 v[52:55], v33 offset:3072
    ds_read_b128 v[108:111], v33 offset:4096
    v_mfma_f32_16x16x32_bf16 v[100:103], v[64:67], v[172:175], v[100:103]
    buffer_load_dwordx4 v[64:67], v27, s[8:11], s45 offen offset:0 sc1
    ds_read_b128 v[112:115], v33 offset:5120
    s_waitcnt vmcnt(7)
    v_mfma_f32_16x16x32_bf16 v[88:91], v[68:71], v[176:179], v[88:91]
    ds_read_b128 v[116:119], v33 offset:6144
    s_waitcnt lgkmcnt(3)
    v_add_f32 v104, v104, v40
    v_add_f32 v105, v105, v41
    v_mfma_f32_16x16x32_bf16 v[92:95], v[68:71], v[180:183], v[92:95]
    v_add_f32 v106, v106, v42
    v_add_f32 v107, v107, v43
    v_add_f32 v104, v104, v44
    v_add_f32 v105, v105, v45
    v_add_f32 v106, v106, v46
    v_mfma_f32_16x16x32_bf16 v[96:99], v[68:71], v[184:187], v[96:99]
    v_add_f32 v107, v107, v47
    v_add_f32 v104, v104, v48
    v_add_f32 v105, v105, v49
    v_add_f32 v106, v106, v50
    v_add_f32 v107, v107, v51
    v_mfma_f32_16x16x32_bf16 v[100:103], v[68:71], v[188:191], v[100:103]
    buffer_load_dwordx4 v[68:71], v27, s[8:11], s45 offen offset:1024 sc1
    v_add_f32 v104, v104, v52
    v_add_f32 v105, v105, v53
    s_waitcnt vmcnt(7)
    v_mfma_f32_16x16x32_bf16 v[88:91], v[72:75], v[192:195], v[88:91]
    v_add_f32 v106, v106, v54
    v_add_f32 v107, v107, v55
    s_waitcnt lgkmcnt(0)
    v_add_f32 v104, v104, v108
    v_add_f32 v105, v105, v109
    v_mfma_f32_16x16x32_bf16 v[92:95], v[72:75], v[196:199], v[92:95]
    v_add_f32 v106, v106, v110
    v_add_f32 v107, v107, v111
    v_add_f32 v104, v104, v112
    v_add_f32 v105, v105, v113
    v_add_f32_e64 v106, v106, v114
    v_mfma_f32_16x16x32_bf16 v[96:99], v[72:75], v[200:203], v[96:99]
    v_add_f32 v107, v107, v115
    v_add_f32 v104, v104, v116
    v_add_f32 v105, v105, v117
    v_add_f32 v106, v106, v118
    v_add_f32 v107, v107, v119
    v_mfma_f32_16x16x32_bf16 v[100:103], v[72:75], v[204:207], v[100:103]
    buffer_load_dwordx4 v[72:75], v28, s[8:11], s45 offen offset:0 sc1
    v_mul_f32 v104, v120, v104
    v_mul_f32 v105, v121, v105
    s_waitcnt vmcnt(7)
    v_mfma_f32_16x16x32_bf16 v[88:91], v[76:79], v[208:211], v[88:91]
    v_mul_f32 v106, v122, v106
    v_mul_f32 v107, v123, v107
    v_cvt_pk_bf16_f32 v10, v104, v105
    v_cvt_pk_bf16_f32 v11, v106, v107
    v_mfma_f32_16x16x32_bf16 v[92:95], v[76:79], v[212:215], v[92:95]
    buffer_store_dwordx4 v[8:11], v1, s[8:11], s37 offen offset:0 sc1
    v_lshlrev_b32 v120, 16, v16
    v_and_b32 v121, s61, v16
    v_mfma_f32_16x16x32_bf16 v[96:99], v[76:79], v[216:219], v[96:99]
    v_lshlrev_b32 v122, 16, v17
    v_and_b32 v123, s61, v17
    v_mul_f32 v124, v120, v120
    v_mul_f32 v125, v121, v121
    v_mul_f32 v126, v122, v122
    v_mfma_f32_16x16x32_bf16 v[100:103], v[76:79], v[220:223], v[100:103]
    buffer_load_dwordx4 v[76:79], v28, s[8:11], s45 offen offset:1024 sc1
    v_mul_f32_e64 v127, v123, v123
    v_fma_f32 v124, v124, s39, v38
    s_waitcnt vmcnt(8)
    v_mfma_f32_16x16x32_bf16 v[88:91], v[80:83], v[224:227], v[88:91]
    v_fma_f32 v125, v125, s39, v38
    v_fma_f32 v126, v126, s39, v38
    v_fma_f32 v127, v127, s39, v38
    v_mul_f32 v124, v124, v120
    v_mul_f32 v125, v125, v121
    v_mfma_f32_16x16x32_bf16 v[92:95], v[80:83], v[228:231], v[92:95]
    v_mul_f32 v126, v126, v122
    v_mul_f32 v127, v127, v123
    v_exp_f32 v124, v124
    v_mfma_f32_16x16x32_bf16 v[96:99], v[80:83], v[232:235], v[96:99]
    v_exp_f32 v125, v125
    v_exp_f32_e64 v126, v126
    v_mfma_f32_16x16x32_bf16 v[100:103], v[80:83], v[236:239], v[100:103]
    buffer_load_dwordx4 v[80:83], v29, s[8:11], s45 offen offset:0 sc1
    v_exp_f32 v127, v127
    s_waitcnt vmcnt(8)
    v_mfma_f32_16x16x32_bf16 v[88:91], v[84:87], v[240:243], v[88:91]
    v_add_f32 v124, 1.0, v124
    v_add_f32 v125, 1.0, v125
    v_add_f32 v126, 1.0, v126
    v_add_f32 v127, 1.0, v127
    v_mfma_f32_16x16x32_bf16 v[92:95], v[84:87], v[244:247], v[92:95]
    v_rcp_f32 v124, v124
    v_rcp_f32 v125, v125
    v_mfma_f32_16x16x32_bf16 v[96:99], v[84:87], v[248:251], v[96:99]
    v_rcp_f32 v126, v126
    v_rcp_f32 v127, v127
    v_mul_f32 v120, v124, v120
    v_mfma_f32_16x16x32_bf16 v[100:103], v[84:87], v[252:255], v[100:103]
    buffer_load_dwordx4 v[84:87], v29, s[8:11], s45 offen offset:1024 sc1
    v_mul_f32 v121, v125, v121
    v_mul_f32 v122, v126, v122
    s_waitcnt vmcnt(8)
    v_mfma_f32_16x16x32_bf16 v[104:107], v[56:59], v[128:131], v[4:7]
    v_mul_f32_e64 v123, v127, v123
    v_mfma_f32_16x16x32_bf16 v[108:111], v[56:59], v[132:135], 0
    v_mfma_f32_16x16x32_bf16 v[112:115], v[56:59], v[136:139], 0
    ds_write_b128 v30, v[92:95] offset:28672
    v_mfma_f32_16x16x32_bf16 v[116:119], v[56:59], v[140:143], 0
    buffer_load_dwordx4 v[56:59], v26, s[8:11], s46 offen offset:0 sc1
    ds_write_b128 v31, v[96:99] offset:28672
    s_waitcnt vmcnt(8)
    v_mfma_f32_16x16x32_bf16 v[104:107], v[60:63], v[144:147], v[104:107]
    ds_write_b128 v32, v[100:103] offset:28672
    v_mfma_f32_16x16x32_bf16 v[108:111], v[60:63], v[148:151], v[108:111]
    v_mfma_f32_16x16x32_bf16 v[112:115], v[60:63], v[152:155], v[112:115]
    v_mfma_f32_16x16x32_bf16 v[116:119], v[60:63], v[156:159], v[116:119]
    buffer_load_dwordx4 v[60:63], v26, s[8:11], s46 offen offset:1024 sc1
    s_waitcnt vmcnt(8)
    v_mfma_f32_16x16x32_bf16 v[104:107], v[64:67], v[160:163], v[104:107]
    v_mfma_f32_16x16x32_bf16 v[108:111], v[64:67], v[164:167], v[108:111]
    s_waitcnt lgkmcnt(0)
    s_barrier
    ds_read_b128 v[40:43], v33 offset:28672
    ds_read_b128 v[44:47], v33 offset:29696
    v_mfma_f32_16x16x32_bf16 v[112:115], v[64:67], v[168:171], v[112:115]
    ds_read_b128 v[48:51], v33 offset:30720
    ds_read_b128 v[52:55], v33 offset:31744
    ds_read_b128 v[92:95], v33 offset:32768
    v_mfma_f32_16x16x32_bf16 v[116:119], v[64:67], v[172:175], v[116:119]
    buffer_load_dwordx4 v[64:67], v27, s[8:11], s46 offen offset:0 sc1
    ds_read_b128 v[96:99], v33 offset:33792
    s_waitcnt vmcnt(8)
    v_mfma_f32_16x16x32_bf16 v[104:107], v[68:71], v[176:179], v[104:107]
    ds_read_b128 v[100:103], v33 offset:34816
    s_waitcnt lgkmcnt(3)
    v_add_f32 v88, v88, v40
    v_add_f32 v89, v89, v41
    v_mfma_f32_16x16x32_bf16 v[108:111], v[68:71], v[180:183], v[108:111]
    v_add_f32 v90, v90, v42
    v_add_f32 v91, v91, v43
    v_add_f32 v88, v88, v44
    v_add_f32 v89, v89, v45
    v_add_f32 v90, v90, v46
    v_mfma_f32_16x16x32_bf16 v[112:115], v[68:71], v[184:187], v[112:115]
    v_add_f32 v91, v91, v47
    v_add_f32 v88, v88, v48
    v_add_f32 v89, v89, v49
    v_add_f32 v90, v90, v50
    v_add_f32 v91, v91, v51
    v_mfma_f32_16x16x32_bf16 v[116:119], v[68:71], v[188:191], v[116:119]
    buffer_load_dwordx4 v[68:71], v27, s[8:11], s46 offen offset:1024 sc1
    v_add_f32 v88, v88, v52
    v_add_f32_e64 v89, v89, v53
    s_waitcnt vmcnt(8)
    v_mfma_f32_16x16x32_bf16 v[104:107], v[72:75], v[192:195], v[104:107]
    v_add_f32 v90, v90, v54
    v_add_f32 v91, v91, v55
    s_waitcnt lgkmcnt(0)
    v_add_f32 v88, v88, v92
    v_add_f32 v89, v89, v93
    v_mfma_f32_16x16x32_bf16 v[108:111], v[72:75], v[196:199], v[108:111]
    v_add_f32 v90, v90, v94
    v_add_f32 v91, v91, v95
    v_add_f32 v88, v88, v96
    v_add_f32 v89, v89, v97
    v_add_f32 v90, v90, v98
    v_mfma_f32_16x16x32_bf16 v[112:115], v[72:75], v[200:203], v[112:115]
    v_add_f32 v91, v91, v99
    v_add_f32 v88, v88, v100
    v_add_f32 v89, v89, v101
    v_add_f32 v90, v90, v102
    v_add_f32 v91, v91, v103
    v_mfma_f32_16x16x32_bf16 v[116:119], v[72:75], v[204:207], v[116:119]
    buffer_load_dwordx4 v[72:75], v28, s[8:11], s46 offen offset:0 sc1
    v_mul_f32 v88, v120, v88
    v_mul_f32 v89, v121, v89
    s_waitcnt vmcnt(7)
    v_mfma_f32_16x16x32_bf16 v[104:107], v[76:79], v[208:211], v[104:107]
    v_mul_f32 v90, v122, v90
    v_mul_f32 v91, v123, v91
    v_cvt_pk_bf16_f32 v8, v88, v89
    v_cvt_pk_bf16_f32 v9, v90, v91
    v_lshlrev_b32 v120, 16, v18
    v_mfma_f32_16x16x32_bf16 v[108:111], v[76:79], v[212:215], v[108:111]
    v_and_b32 v121, s61, v18
    v_lshlrev_b32 v122, 16, v19
    v_and_b32 v123, s61, v19
    v_mul_f32 v124, v120, v120
    v_mul_f32 v125, v121, v121
    v_mfma_f32_16x16x32_bf16 v[112:115], v[76:79], v[216:219], v[112:115]
    v_mul_f32 v126, v122, v122
    v_mul_f32 v127, v123, v123
    v_fma_f32 v124, v124, s39, v38
    v_fma_f32 v125, v125, s39, v38
    v_fma_f32 v126, v126, s39, v38
    v_mfma_f32_16x16x32_bf16 v[116:119], v[76:79], v[220:223], v[116:119]
    buffer_load_dwordx4 v[76:79], v28, s[8:11], s46 offen offset:1024 sc1
    v_fma_f32 v127, v127, s39, v38
    v_mul_f32 v124, v124, v120
    s_waitcnt vmcnt(7)
    v_mfma_f32_16x16x32_bf16 v[104:107], v[80:83], v[224:227], v[104:107]
    v_mul_f32 v125, v125, v121
    v_mul_f32 v126, v126, v122
    v_mul_f32 v127, v127, v123
    v_exp_f32 v124, v124
    v_mfma_f32_16x16x32_bf16 v[108:111], v[80:83], v[228:231], v[108:111]
    v_exp_f32 v125, v125
    v_exp_f32 v126, v126
    v_mfma_f32_16x16x32_bf16 v[112:115], v[80:83], v[232:235], v[112:115]
    v_exp_f32 v127, v127
    v_add_f32 v124, 1.0, v124
    v_add_f32 v125, 1.0, v125
    v_add_f32 v126, 1.0, v126
    v_mfma_f32_16x16x32_bf16 v[116:119], v[80:83], v[236:239], v[116:119]
    buffer_load_dwordx4 v[80:83], v29, s[8:11], s46 offen offset:0 sc1
    v_add_f32 v127, 1.0, v127
    s_waitcnt vmcnt(7)
    v_mfma_f32_16x16x32_bf16 v[104:107], v[84:87], v[240:243], v[104:107]
    v_rcp_f32 v124, v124
    v_rcp_f32 v125, v125
    v_mfma_f32_16x16x32_bf16 v[108:111], v[84:87], v[244:247], v[108:111]
    v_rcp_f32 v126, v126
    v_rcp_f32 v127, v127
    v_mul_f32 v120, v124, v120
    v_mfma_f32_16x16x32_bf16 v[112:115], v[84:87], v[248:251], v[112:115]
    v_mul_f32 v121, v125, v121
    v_mul_f32 v122, v126, v122
    v_mul_f32_e64 v123, v127, v123
    v_mfma_f32_16x16x32_bf16 v[116:119], v[84:87], v[252:255], v[116:119]
    buffer_load_dwordx4 v[84:87], v29, s[8:11], s46 offen offset:1024 sc1
    s_waitcnt vmcnt(7)
    v_mfma_f32_16x16x32_bf16 v[88:91], v[56:59], v[128:131], v[4:7]
    v_mfma_f32_16x16x32_bf16 v[92:95], v[56:59], v[132:135], 0
    v_mfma_f32_16x16x32_bf16 v[96:99], v[56:59], v[136:139], 0
    ds_write_b128 v30, v[108:111] offset:0
    v_mfma_f32_16x16x32_bf16 v[100:103], v[56:59], v[140:143], 0
    buffer_load_dwordx4 v[56:59], v26, s[8:11], s47 offen offset:0 sc1
    ds_write_b128 v31, v[112:115] offset:0
    s_waitcnt vmcnt(7)
    v_mfma_f32_16x16x32_bf16 v[88:91], v[60:63], v[144:147], v[88:91]
    ds_write_b128 v32, v[116:119] offset:0
    v_mfma_f32_16x16x32_bf16 v[92:95], v[60:63], v[148:151], v[92:95]
    v_mfma_f32_16x16x32_bf16 v[96:99], v[60:63], v[152:155], v[96:99]
    v_mfma_f32_16x16x32_bf16 v[100:103], v[60:63], v[156:159], v[100:103]
    buffer_load_dwordx4 v[60:63], v26, s[8:11], s47 offen offset:1024 sc1
    s_waitcnt vmcnt(7)
    v_mfma_f32_16x16x32_bf16 v[88:91], v[64:67], v[160:163], v[88:91]
    v_mfma_f32_16x16x32_bf16 v[92:95], v[64:67], v[164:167], v[92:95]
    s_waitcnt lgkmcnt(0)
    s_barrier
    ds_read_b128 v[40:43], v33 offset:0
    ds_read_b128 v[44:47], v33 offset:1024
    v_mfma_f32_16x16x32_bf16 v[96:99], v[64:67], v[168:171], v[96:99]
    ds_read_b128 v[48:51], v33 offset:2048
    ds_read_b128 v[52:55], v33 offset:3072
    ds_read_b128 v[108:111], v33 offset:4096
    v_mfma_f32_16x16x32_bf16 v[100:103], v[64:67], v[172:175], v[100:103]
    buffer_load_dwordx4 v[64:67], v27, s[8:11], s47 offen offset:0 sc1
    ds_read_b128 v[112:115], v33 offset:5120
    s_waitcnt vmcnt(7)
    v_mfma_f32_16x16x32_bf16 v[88:91], v[68:71], v[176:179], v[88:91]
    ds_read_b128 v[116:119], v33 offset:6144
    s_waitcnt lgkmcnt(3)
    v_add_f32 v104, v104, v40
    v_add_f32 v105, v105, v41
    v_mfma_f32_16x16x32_bf16 v[92:95], v[68:71], v[180:183], v[92:95]
    v_add_f32 v106, v106, v42
    v_add_f32 v107, v107, v43
    v_add_f32 v104, v104, v44
    v_add_f32 v105, v105, v45
    v_add_f32 v106, v106, v46
    v_mfma_f32_16x16x32_bf16 v[96:99], v[68:71], v[184:187], v[96:99]
    v_add_f32 v107, v107, v47
    v_add_f32 v104, v104, v48
    v_add_f32 v105, v105, v49
    v_add_f32 v106, v106, v50
    v_add_f32 v107, v107, v51
    v_mfma_f32_16x16x32_bf16 v[100:103], v[68:71], v[188:191], v[100:103]
    buffer_load_dwordx4 v[68:71], v27, s[8:11], s47 offen offset:1024 sc1
    v_add_f32 v104, v104, v52
    v_add_f32 v105, v105, v53
    s_waitcnt vmcnt(7)
    v_mfma_f32_16x16x32_bf16 v[88:91], v[72:75], v[192:195], v[88:91]
    v_add_f32 v106, v106, v54
    v_add_f32 v107, v107, v55
    s_waitcnt lgkmcnt(0)
    v_add_f32 v104, v104, v108
    v_add_f32 v105, v105, v109
    v_mfma_f32_16x16x32_bf16 v[92:95], v[72:75], v[196:199], v[92:95]
    v_add_f32 v106, v106, v110
    v_add_f32 v107, v107, v111
    v_add_f32 v104, v104, v112
    v_add_f32 v105, v105, v113
    v_add_f32 v106, v106, v114
    v_mfma_f32_16x16x32_bf16 v[96:99], v[72:75], v[200:203], v[96:99]
    v_add_f32 v107, v107, v115
    v_add_f32 v104, v104, v116
    v_add_f32 v105, v105, v117
    v_add_f32 v106, v106, v118
    v_add_f32 v107, v107, v119
    v_mfma_f32_16x16x32_bf16 v[100:103], v[72:75], v[204:207], v[100:103]
    buffer_load_dwordx4 v[72:75], v28, s[8:11], s47 offen offset:0 sc1
    v_mul_f32 v104, v120, v104
    v_mul_f32 v105, v121, v105
    s_waitcnt vmcnt(7)
    v_mfma_f32_16x16x32_bf16 v[88:91], v[76:79], v[208:211], v[88:91]
    v_mul_f32 v106, v122, v106
    v_mul_f32_e64 v107, v123, v107
    v_cvt_pk_bf16_f32 v10, v104, v105
    v_cvt_pk_bf16_f32 v11, v106, v107
    v_mfma_f32_16x16x32_bf16 v[92:95], v[76:79], v[212:215], v[92:95]
    buffer_store_dwordx4 v[8:11], v1, s[8:11], s37 offen offset:1024 sc1
    v_lshlrev_b32 v120, 16, v20
    v_and_b32 v121, s61, v20
    v_mfma_f32_16x16x32_bf16 v[96:99], v[76:79], v[216:219], v[96:99]
    v_lshlrev_b32 v122, 16, v21
    v_and_b32 v123, s61, v21
    v_mul_f32 v124, v120, v120
    v_mul_f32 v125, v121, v121
    v_mul_f32 v126, v122, v122
    v_mfma_f32_16x16x32_bf16 v[100:103], v[76:79], v[220:223], v[100:103]
    buffer_load_dwordx4 v[76:79], v28, s[8:11], s47 offen offset:1024 sc1
    v_mul_f32 v127, v123, v123
    v_fma_f32 v124, v124, s39, v38
    s_waitcnt vmcnt(8)
    v_mfma_f32_16x16x32_bf16 v[88:91], v[80:83], v[224:227], v[88:91]
    v_fma_f32 v125, v125, s39, v38
    v_fma_f32 v126, v126, s39, v38
    v_fma_f32 v127, v127, s39, v38
    v_mul_f32 v124, v124, v120
    v_mul_f32 v125, v125, v121
    v_mfma_f32_16x16x32_bf16 v[92:95], v[80:83], v[228:231], v[92:95]
    v_mul_f32 v126, v126, v122
    v_mul_f32 v127, v127, v123
    v_exp_f32 v124, v124
    v_mfma_f32_16x16x32_bf16 v[96:99], v[80:83], v[232:235], v[96:99]
    v_exp_f32 v125, v125
    v_exp_f32 v126, v126
    v_mfma_f32_16x16x32_bf16 v[100:103], v[80:83], v[236:239], v[100:103]
    buffer_load_dwordx4 v[80:83], v29, s[8:11], s47 offen offset:0 sc1
    v_exp_f32 v127, v127
    s_waitcnt vmcnt(8)
    v_mfma_f32_16x16x32_bf16 v[88:91], v[84:87], v[240:243], v[88:91]
    v_add_f32 v124, 1.0, v124
    v_add_f32 v125, 1.0, v125
    v_add_f32 v126, 1.0, v126
    v_add_f32 v127, 1.0, v127
    v_mfma_f32_16x16x32_bf16 v[92:95], v[84:87], v[244:247], v[92:95]
    v_rcp_f32 v124, v124
    v_rcp_f32 v125, v125
    v_mfma_f32_16x16x32_bf16 v[96:99], v[84:87], v[248:251], v[96:99]
    v_rcp_f32 v126, v126
    v_rcp_f32 v127, v127
    v_mul_f32 v120, v124, v120
    v_mfma_f32_16x16x32_bf16 v[100:103], v[84:87], v[252:255], v[100:103]
    buffer_load_dwordx4 v[84:87], v29, s[8:11], s47 offen offset:1024 sc1
    v_mul_f32 v121, v125, v121
    v_mul_f32 v122, v126, v122
    s_waitcnt vmcnt(8)
    v_mfma_f32_16x16x32_bf16 v[104:107], v[56:59], v[128:131], v[4:7]
    v_mul_f32_e64 v123, v127, v123
    v_mfma_f32_16x16x32_bf16 v[108:111], v[56:59], v[132:135], 0
    v_mfma_f32_16x16x32_bf16 v[112:115], v[56:59], v[136:139], 0
    ds_write_b128 v30, v[92:95] offset:28672
    v_mfma_f32_16x16x32_bf16 v[116:119], v[56:59], v[140:143], 0
    buffer_load_dwordx4 v[56:59], v26, s[8:11], s48 offen offset:0 sc1
    ds_write_b128 v31, v[96:99] offset:28672
    s_waitcnt vmcnt(8)
    v_mfma_f32_16x16x32_bf16 v[104:107], v[60:63], v[144:147], v[104:107]
    ds_write_b128 v32, v[100:103] offset:28672
    v_mfma_f32_16x16x32_bf16 v[108:111], v[60:63], v[148:151], v[108:111]
    v_mfma_f32_16x16x32_bf16 v[112:115], v[60:63], v[152:155], v[112:115]
    v_mfma_f32_16x16x32_bf16 v[116:119], v[60:63], v[156:159], v[116:119]
    buffer_load_dwordx4 v[60:63], v26, s[8:11], s48 offen offset:1024 sc1
    s_waitcnt vmcnt(8)
    v_mfma_f32_16x16x32_bf16 v[104:107], v[64:67], v[160:163], v[104:107]
    v_mfma_f32_16x16x32_bf16 v[108:111], v[64:67], v[164:167], v[108:111]
    s_waitcnt lgkmcnt(0)
    s_barrier
    ds_read_b128 v[40:43], v33 offset:28672
    ds_read_b128 v[44:47], v33 offset:29696
    v_mfma_f32_16x16x32_bf16 v[112:115], v[64:67], v[168:171], v[112:115]
    ds_read_b128 v[48:51], v33 offset:30720
    ds_read_b128 v[52:55], v33 offset:31744
    ds_read_b128 v[92:95], v33 offset:32768
    v_mfma_f32_16x16x32_bf16 v[116:119], v[64:67], v[172:175], v[116:119]
    buffer_load_dwordx4 v[64:67], v27, s[8:11], s48 offen offset:0 sc1
    ds_read_b128 v[96:99], v33 offset:33792
    s_waitcnt vmcnt(8)
    v_mfma_f32_16x16x32_bf16 v[104:107], v[68:71], v[176:179], v[104:107]
    ds_read_b128 v[100:103], v33 offset:34816
    s_waitcnt lgkmcnt(3)
    v_add_f32 v88, v88, v40
    v_add_f32 v89, v89, v41
    v_mfma_f32_16x16x32_bf16 v[108:111], v[68:71], v[180:183], v[108:111]
    v_add_f32 v90, v90, v42
    v_add_f32 v91, v91, v43
    v_add_f32 v88, v88, v44
    v_add_f32 v89, v89, v45
    v_add_f32 v90, v90, v46
    v_mfma_f32_16x16x32_bf16 v[112:115], v[68:71], v[184:187], v[112:115]
    v_add_f32 v91, v91, v47
    v_add_f32 v88, v88, v48
    v_add_f32 v89, v89, v49
    v_add_f32 v90, v90, v50
    v_add_f32 v91, v91, v51
    v_mfma_f32_16x16x32_bf16 v[116:119], v[68:71], v[188:191], v[116:119]
    buffer_load_dwordx4 v[68:71], v27, s[8:11], s48 offen offset:1024 sc1
    v_add_f32 v88, v88, v52
    v_add_f32 v89, v89, v53
    s_waitcnt vmcnt(8)
    v_mfma_f32_16x16x32_bf16 v[104:107], v[72:75], v[192:195], v[104:107]
    v_add_f32 v90, v90, v54
    v_add_f32 v91, v91, v55
    s_waitcnt lgkmcnt(0)
    v_add_f32 v88, v88, v92
    v_add_f32 v89, v89, v93
    v_mfma_f32_16x16x32_bf16 v[108:111], v[72:75], v[196:199], v[108:111]
    v_add_f32 v90, v90, v94
    v_add_f32 v91, v91, v95
    v_add_f32 v88, v88, v96
    v_add_f32 v89, v89, v97
    v_add_f32 v90, v90, v98
    v_mfma_f32_16x16x32_bf16 v[112:115], v[72:75], v[200:203], v[112:115]
    v_add_f32 v91, v91, v99
    v_add_f32 v88, v88, v100
    v_add_f32 v89, v89, v101
    v_add_f32 v90, v90, v102
    v_add_f32 v91, v91, v103
    v_mfma_f32_16x16x32_bf16 v[116:119], v[72:75], v[204:207], v[116:119]
    buffer_load_dwordx4 v[72:75], v28, s[8:11], s48 offen offset:0 sc1
    s_waitcnt vmcnt(8)
    s_waitcnt vmcnt(7)
    v_mfma_f32_16x16x32_bf16 v[104:107], v[76:79], v[208:211], v[104:107]
    buffer_store_dwordx2 v[2:3], v34, s[8:11], s56 offen sc1
    s_add_u32 s56, s56, 131072
    v_mul_f32 v88, v120, v88
    v_mfma_f32_16x16x32_bf16 v[108:111], v[76:79], v[212:215], v[108:111]
    v_mul_f32 v89, v121, v89
    v_mul_f32 v90, v122, v90
    v_mul_f32 v91, v123, v91
    v_cvt_pk_bf16_f32 v8, v88, v89
    v_cvt_pk_bf16_f32 v9, v90, v91
    v_mfma_f32_16x16x32_bf16 v[112:115], v[76:79], v[216:219], v[112:115]
    v_lshlrev_b32 v120, 16, v22
    v_and_b32 v121, s61, v22
    v_lshlrev_b32 v122, 16, v23
    v_and_b32 v123, s61, v23
    v_mul_f32 v124, v120, v120
    v_mfma_f32_16x16x32_bf16 v[116:119], v[76:79], v[220:223], v[116:119]
    buffer_load_dwordx4 v[76:79], v28, s[8:11], s48 offen offset:1024 sc1
    v_mul_f32 v125, v121, v121
    v_mul_f32 v126, v122, v122
    s_waitcnt vmcnt(8)
    v_mfma_f32_16x16x32_bf16 v[104:107], v[80:83], v[224:227], v[104:107]
    v_mul_f32 v127, v123, v123
    v_fma_f32 v124, v124, s39, v38
    v_fma_f32 v125, v125, s39, v38
    v_fma_f32 v126, v126, s39, v38
    v_fma_f32 v127, v127, s39, v38
    v_mfma_f32_16x16x32_bf16 v[108:111], v[80:83], v[228:231], v[108:111]
    v_mul_f32 v124, v124, v120
    v_mul_f32 v125, v125, v121
    v_mul_f32 v126, v126, v122
    v_mul_f32_e64 v127, v127, v123
    v_mfma_f32_16x16x32_bf16 v[112:115], v[80:83], v[232:235], v[112:115]
    v_exp_f32 v124, v124
    v_exp_f32 v125, v125
    v_mfma_f32_16x16x32_bf16 v[116:119], v[80:83], v[236:239], v[116:119]
    buffer_load_dwordx4 v[80:83], v29, s[8:11], s48 offen offset:0 sc1
    v_exp_f32 v126, v126
    s_waitcnt vmcnt(8)
    v_mfma_f32_16x16x32_bf16 v[104:107], v[84:87], v[240:243], v[104:107]
    v_exp_f32 v127, v127
    v_add_f32 v124, 1.0, v124
    v_add_f32 v125, 1.0, v125
    v_add_f32 v126, 1.0, v126
    v_mfma_f32_16x16x32_bf16 v[108:111], v[84:87], v[244:247], v[108:111]
    v_add_f32 v127, 1.0, v127
    v_rcp_f32 v124, v124
    v_rcp_f32 v125, v125
    v_mfma_f32_16x16x32_bf16 v[112:115], v[84:87], v[248:251], v[112:115]
    v_rcp_f32 v126, v126
    v_rcp_f32 v127, v127
    v_mul_f32 v120, v124, v120
    v_mfma_f32_16x16x32_bf16 v[116:119], v[84:87], v[252:255], v[116:119]
    buffer_load_dwordx4 v[84:87], v29, s[8:11], s48 offen offset:1024 sc1
    v_mul_f32 v121, v125, v121
    v_mul_f32 v122, v126, v122
    s_waitcnt vmcnt(8)
    v_mfma_f32_16x16x32_bf16 v[88:91], v[56:59], v[128:131], v[4:7]
    v_mul_f32_e64 v123, v127, v123
    v_mfma_f32_16x16x32_bf16 v[92:95], v[56:59], v[132:135], 0
    v_mfma_f32_16x16x32_bf16 v[96:99], v[56:59], v[136:139], 0
    ds_write_b128 v30, v[108:111] offset:0
    v_mfma_f32_16x16x32_bf16 v[100:103], v[56:59], v[140:143], 0
    ds_write_b128 v31, v[112:115] offset:0
    s_waitcnt vmcnt(7)
    v_mfma_f32_16x16x32_bf16 v[88:91], v[60:63], v[144:147], v[88:91]
    ds_write_b128 v32, v[116:119] offset:0
    v_mfma_f32_16x16x32_bf16 v[92:95], v[60:63], v[148:151], v[92:95]
    v_mfma_f32_16x16x32_bf16 v[96:99], v[60:63], v[152:155], v[96:99]
    v_mfma_f32_16x16x32_bf16 v[100:103], v[60:63], v[156:159], v[100:103]
    s_waitcnt vmcnt(6)
    v_mfma_f32_16x16x32_bf16 v[88:91], v[64:67], v[160:163], v[88:91]
    v_mfma_f32_16x16x32_bf16 v[92:95], v[64:67], v[164:167], v[92:95]
    s_waitcnt lgkmcnt(0)
    s_barrier
    ds_read_b128 v[40:43], v33 offset:0
    ds_read_b128 v[44:47], v33 offset:1024
    v_mfma_f32_16x16x32_bf16 v[96:99], v[64:67], v[168:171], v[96:99]
    ds_read_b128 v[48:51], v33 offset:2048
    ds_read_b128 v[52:55], v33 offset:3072
    ds_read_b128 v[108:111], v33 offset:4096
    v_mfma_f32_16x16x32_bf16 v[100:103], v[64:67], v[172:175], v[100:103]
    ds_read_b128 v[112:115], v33 offset:5120
    ds_read_b128 v[116:119], v33 offset:6144
    s_waitcnt lgkmcnt(3)
    v_add_f32 v104, v104, v40
    s_waitcnt vmcnt(5)
    v_mfma_f32_16x16x32_bf16 v[88:91], v[68:71], v[176:179], v[88:91]
    v_add_f32 v105, v105, v41
    v_add_f32 v106, v106, v42
    v_add_f32 v107, v107, v43
    v_add_f32 v104, v104, v44
    v_add_f32 v105, v105, v45
    v_mfma_f32_16x16x32_bf16 v[92:95], v[68:71], v[180:183], v[92:95]
    v_add_f32 v106, v106, v46
    v_add_f32 v107, v107, v47
    v_add_f32 v104, v104, v48
    v_add_f32 v105, v105, v49
    v_add_f32 v106, v106, v50
    v_mfma_f32_16x16x32_bf16 v[96:99], v[68:71], v[184:187], v[96:99]
    v_add_f32 v107, v107, v51
    v_add_f32 v104, v104, v52
    v_add_f32 v105, v105, v53
    v_add_f32 v106, v106, v54
    v_add_f32 v107, v107, v55
    v_mfma_f32_16x16x32_bf16 v[100:103], v[68:71], v[188:191], v[100:103]
    s_waitcnt lgkmcnt(0)
    v_add_f32 v104, v104, v108
    v_add_f32 v105, v105, v109
    v_add_f32 v106, v106, v110
    v_add_f32 v107, v107, v111
    s_waitcnt vmcnt(4)
    v_mfma_f32_16x16x32_bf16 v[88:91], v[72:75], v[192:195], v[88:91]
    v_add_f32 v104, v104, v112
    v_add_f32 v105, v105, v113
    v_add_f32 v106, v106, v114
    v_add_f32 v107, v107, v115
    v_add_f32 v104, v104, v116
    v_mfma_f32_16x16x32_bf16 v[92:95], v[72:75], v[196:199], v[92:95]
    v_add_f32 v105, v105, v117
    v_add_f32 v106, v106, v118
    v_add_f32 v107, v107, v119
    v_mul_f32 v104, v120, v104
    v_mul_f32 v105, v121, v105
    v_mfma_f32_16x16x32_bf16 v[96:99], v[72:75], v[200:203], v[96:99]
    v_mul_f32 v106, v122, v106
    v_mul_f32 v107, v123, v107
    v_cvt_pk_bf16_f32 v10, v104, v105
    v_cvt_pk_bf16_f32 v11, v106, v107
    v_mfma_f32_16x16x32_bf16 v[100:103], v[72:75], v[204:207], v[100:103]
    buffer_store_dwordx4 v[8:11], v1, s[8:11], s37 offen offset:2048 sc1
    v_lshlrev_b32 v120, 16, v24
    v_and_b32 v121, s61, v24
    s_waitcnt vmcnt(3)
    v_mfma_f32_16x16x32_bf16 v[88:91], v[76:79], v[208:211], v[88:91]
    v_lshlrev_b32 v122, 16, v25
    v_and_b32 v123, s61, v25
    v_mul_f32 v124, v120, v120
    v_mul_f32 v125, v121, v121
    v_mul_f32 v126, v122, v122
    v_mfma_f32_16x16x32_bf16 v[92:95], v[76:79], v[212:215], v[92:95]
    v_mul_f32 v127, v123, v123
    v_fma_f32 v124, v124, s39, v38
    v_fma_f32 v125, v125, s39, v38
    v_fma_f32 v126, v126, s39, v38
    v_fma_f32 v127, v127, s39, v38
    v_mfma_f32_16x16x32_bf16 v[96:99], v[76:79], v[216:219], v[96:99]
    v_mul_f32 v124, v124, v120
    v_mul_f32 v125, v125, v121
    v_mul_f32 v126, v126, v122
    v_mul_f32 v127, v127, v123
    v_mfma_f32_16x16x32_bf16 v[100:103], v[76:79], v[220:223], v[100:103]
    v_exp_f32 v124, v124
    v_exp_f32 v125, v125
    s_waitcnt vmcnt(2)
    v_mfma_f32_16x16x32_bf16 v[88:91], v[80:83], v[224:227], v[88:91]
    v_exp_f32 v126, v126
    v_exp_f32 v127, v127
    v_add_f32 v124, 1.0, v124
    v_mfma_f32_16x16x32_bf16 v[92:95], v[80:83], v[228:231], v[92:95]
    v_add_f32 v125, 1.0, v125
    v_add_f32 v126, 1.0, v126
    v_add_f32 v127, 1.0, v127
    v_rcp_f32 v124, v124
    v_mfma_f32_16x16x32_bf16 v[96:99], v[80:83], v[232:235], v[96:99]
    v_rcp_f32 v125, v125
    v_rcp_f32 v126, v126
    v_mfma_f32_16x16x32_bf16 v[100:103], v[80:83], v[236:239], v[100:103]
    v_rcp_f32 v127, v127
    v_mul_f32 v120, v124, v120
    v_mul_f32 v121, v125, v121
    v_mul_f32 v122, v126, v122
    s_waitcnt vmcnt(1)
    v_mfma_f32_16x16x32_bf16 v[88:91], v[84:87], v[240:243], v[88:91]
    v_mul_f32 v123, v127, v123
    v_mfma_f32_16x16x32_bf16 v[92:95], v[84:87], v[244:247], v[92:95]
    v_mfma_f32_16x16x32_bf16 v[96:99], v[84:87], v[248:251], v[96:99]
    v_mfma_f32_16x16x32_bf16 v[100:103], v[84:87], v[252:255], v[100:103]
    s_setprio 2
    s_nop 4
    ds_write_b128 v30, v[92:95] offset:28672
    ds_write_b128 v31, v[96:99] offset:28672
    ds_write_b128 v32, v[100:103] offset:28672
    buffer_load_dwordx2 v[36:37], v35, s[8:11], s41 offen sc1
    s_waitcnt vmcnt(1)
    buffer_store_dwordx2 v[2:3], v34, s[8:11], s56 offen sc1
    s_waitcnt lgkmcnt(0)
    s_barrier
    ds_read_b128 v[40:43], v33 offset:28672
    ds_read_b128 v[44:47], v33 offset:29696
    ds_read_b128 v[48:51], v33 offset:30720
    ds_read_b128 v[52:55], v33 offset:31744
    ds_read_b128 v[92:95], v33 offset:32768
    ds_read_b128 v[96:99], v33 offset:33792
    ds_read_b128 v[100:103], v33 offset:34816
    v_mov_b32 v9, v2
    v_mov_b32 v11, v3
    s_waitcnt lgkmcnt(3)
    v_add_f32 v88, v88, v40
    v_add_f32 v89, v89, v41
    v_add_f32 v90, v90, v42
    v_add_f32 v91, v91, v43
    v_add_f32 v88, v88, v44
    v_add_f32 v89, v89, v45
    v_add_f32 v90, v90, v46
    v_add_f32 v91, v91, v47
    v_add_f32 v88, v88, v48
    v_add_f32 v89, v89, v49
    v_add_f32 v90, v90, v50
    v_add_f32 v91, v91, v51
    v_add_f32 v88, v88, v52
    v_add_f32 v89, v89, v53
    v_add_f32 v90, v90, v54
    v_add_f32 v91, v91, v55
    s_waitcnt lgkmcnt(0)
    v_add_f32 v88, v88, v92
    v_add_f32 v89, v89, v93
    v_add_f32 v90, v90, v94
    v_add_f32 v91, v91, v95
    v_add_f32 v88, v88, v96
    v_add_f32 v89, v89, v97
    v_add_f32 v90, v90, v98
    v_add_f32 v91, v91, v99
    v_add_f32 v88, v88, v100
    v_add_f32 v89, v89, v101
    v_add_f32 v90, v90, v102
    v_add_f32 v91, v91, v103
    v_mul_f32 v88, v120, v88
    v_mul_f32 v89, v121, v89
    v_mul_f32 v90, v122, v90
    v_mul_f32_e64 v91, v123, v91
    v_cvt_pk_bf16_f32 v8, v88, v89
    v_cvt_pk_bf16_f32 v10, v90, v91
    buffer_store_dwordx4 v[8:11], v1, s[8:11], s37 offen offset:3072 sc1
    v_bfe_u32 v121, v0, 2, 4
    v_bfe_u32 v122, v0, 3, 2
    v_and_b32 v123, 3, v0
    v_lshlrev_b32 v121, 7, v121
    v_lshl_add_u32 v121, v123, 3, v121
    v_lshl_add_u32 v128, v122, 5, v121
    v_add_u32 v128, 16384, v128
    v_xor_b32 v129, 32, v128
    v_xor_b32 v130, 64, v128
    v_xor_b32 v131, 96, v128
    s_lshl_b32 s7, s51, 10
    s_add_u32 s7, s7, 17367040
    v_lshl_add_u32 v137, v123, 7, s7
    s_add_u32 s7, s33, 131072
    v_add_u32 v138, s7, v1
    s_setprio 0
    s_mov_b32 s40, 0
recurrent_scan__ssm_conv_s4d__mixer_gmlp__prompt_kernel_s4aG_chk:
    s_waitcnt vmcnt(2)
    v_cmp_ne_u64 vcc, v[36:37], v[2:3]
    s_nop 1
    s_cbranch_vccnz recurrent_scan__ssm_conv_s4d__mixer_gmlp__prompt_kernel_s4aG_retry
recurrent_scan__ssm_conv_s4d__mixer_gmlp__prompt_kernel_s4aG_ok:
    s_add_u32 s7, s50, 0
    buffer_load_dwordx4 v[56:59], v1, s[8:11], s7 offen offset:0 sc1
    buffer_load_dwordx4 v[60:63], v1, s[8:11], s7 offen offset:1024 sc1
    s_add_u32 s7, s50, 4096
    buffer_load_dwordx4 v[64:67], v1, s[8:11], s7 offen offset:0 sc1
    buffer_load_dwordx4 v[68:71], v1, s[8:11], s7 offen offset:1024 sc1
    ds_read_b64_tr_b16 v[144:145], v128 offset:0
    ds_read_b64_tr_b16 v[146:147], v128 offset:2048
    ds_read_b64_tr_b16 v[148:149], v129 offset:0
    ds_read_b64_tr_b16 v[150:151], v129 offset:2048
    ds_read_b64_tr_b16 v[152:153], v130 offset:0
    ds_read_b64_tr_b16 v[154:155], v130 offset:2048
    ds_read_b64_tr_b16 v[156:157], v131 offset:0
    ds_read_b64_tr_b16 v[158:159], v131 offset:2048
    ds_read_b64_tr_b16 v[160:161], v128 offset:4096
    ds_read_b64_tr_b16 v[162:163], v128 offset:6144
    ds_read_b64_tr_b16 v[164:165], v129 offset:4096
    ds_read_b64_tr_b16 v[166:167], v129 offset:6144
    ds_read_b64_tr_b16 v[168:169], v130 offset:4096
    ds_read_b64_tr_b16 v[170:171], v130 offset:6144
    ds_read_b64_tr_b16 v[172:173], v131 offset:4096
    ds_read_b64_tr_b16 v[174:175], v131 offset:6144
    ds_read_b64_tr_b16 v[176:177], v128 offset:14336
    ds_read_b64_tr_b16 v[178:179], v128 offset:16384
    ds_read_b64_tr_b16 v[180:181], v129 offset:14336
    ds_read_b64_tr_b16 v[182:183], v129 offset:16384
    ds_read_b64_tr_b16 v[184:185], v130 offset:14336
    ds_read_b64_tr_b16 v[186:187], v130 offset:16384
    ds_read_b64_tr_b16 v[188:189], v131 offset:14336
    ds_read_b64_tr_b16 v[190:191], v131 offset:16384
    ds_read_b64_tr_b16 v[192:193], v128 offset:18432
    ds_read_b64_tr_b16 v[194:195], v128 offset:20480
    ds_read_b64_tr_b16 v[196:197], v129 offset:18432
    ds_read_b64_tr_b16 v[198:199], v129 offset:20480
    ds_read_b64_tr_b16 v[200:201], v130 offset:18432
    ds_read_b64_tr_b16 v[202:203], v130 offset:20480
    ds_read_b64_tr_b16 v[204:205], v131 offset:18432
    ds_read_b64_tr_b16 v[206:207], v131 offset:20480
    ds_read_b64_tr_b16 v[208:209], v128 offset:28672
    ds_read_b64_tr_b16 v[210:211], v128 offset:30720
    ds_read_b64_tr_b16 v[212:213], v129 offset:28672
    ds_read_b64_tr_b16 v[214:215], v129 offset:30720
    ds_read_b64_tr_b16 v[216:217], v130 offset:28672
    ds_read_b64_tr_b16 v[218:219], v130 offset:30720
    ds_read_b64_tr_b16 v[220:221], v131 offset:28672
    ds_read_b64_tr_b16 v[222:223], v131 offset:30720
    ds_read_b64_tr_b16 v[224:225], v128 offset:32768
    ds_read_b64_tr_b16 v[226:227], v128 offset:34816
    ds_read_b64_tr_b16 v[228:229], v129 offset:32768
    ds_read_b64_tr_b16 v[230:231], v129 offset:34816
    ds_read_b64_tr_b16 v[232:233], v130 offset:32768
    ds_read_b64_tr_b16 v[234:235], v130 offset:34816
    ds_read_b64_tr_b16 v[236:237], v131 offset:32768
    ds_read_b64_tr_b16 v[238:239], v131 offset:34816
    s_barrier
    buffer_load_dwordx2 v[36:37], v137, s[8:11], 0 offen sc1
    s_waitcnt lgkmcnt(15)
    s_add_u32 s7, s50, 8192
    s_waitcnt vmcnt(4)
    v_mfma_f32_16x16x32_bf16 v[112:115], v[144:147], v[56:59], 0
    v_mfma_f32_16x16x32_bf16 v[116:119], v[148:151], v[56:59], 0
    v_mfma_f32_16x16x32_bf16 v[120:123], v[152:155], v[56:59], 0
    v_mfma_f32_16x16x32_bf16 v[124:127], v[156:159], v[56:59], 0
    buffer_load_dwordx4 v[72:75], v1, s[8:11], s7 offen offset:0 sc1
    s_waitcnt vmcnt(4)
    v_mfma_f32_16x16x32_bf16 v[112:115], v[160:163], v[60:63], v[112:115]
    v_mfma_f32_16x16x32_bf16 v[116:119], v[164:167], v[60:63], v[116:119]
    v_mfma_f32_16x16x32_bf16 v[120:123], v[168:171], v[60:63], v[120:123]
    v_mfma_f32_16x16x32_bf16 v[124:127], v[172:175], v[60:63], v[124:127]
    ds_read_b64_tr_b16 v[144:145], v128 offset:43008
    buffer_load_dwordx4 v[76:79], v1, s[8:11], s7 offen offset:1024 sc1
    ds_read_b64_tr_b16 v[146:147], v128 offset:45056
    ds_read_b64_tr_b16 v[148:149], v129 offset:43008
    ds_read_b64_tr_b16 v[150:151], v129 offset:45056
    ds_read_b64_tr_b16 v[152:153], v130 offset:43008
    ds_read_b64_tr_b16 v[154:155], v130 offset:45056
    s_add_u32 s7, s50, 12288
    ds_read_b64_tr_b16 v[156:157], v131 offset:43008
    ds_read_b64_tr_b16 v[158:159], v131 offset:45056
    s_waitcnt vmcnt(4)
    v_mfma_f32_16x16x32_bf16 v[112:115], v[176:179], v[64:67], v[112:115]
    v_mfma_f32_16x16x32_bf16 v[116:119], v[180:183], v[64:67], v[116:119]
    buffer_load_dwordx4 v[80:83], v1, s[8:11], s7 offen offset:0 sc1
    v_mfma_f32_16x16x32_bf16 v[120:123], v[184:187], v[64:67], v[120:123]
    v_mfma_f32_16x16x32_bf16 v[124:127], v[188:191], v[64:67], v[124:127]
    ds_read_b64_tr_b16 v[160:161], v128 offset:47104
    ds_read_b64_tr_b16 v[162:163], v128 offset:49152
    ds_read_b64_tr_b16 v[164:165], v129 offset:47104
    buffer_load_dwordx4 v[84:87], v1, s[8:11], s7 offen offset:1024 sc1
    ds_read_b64_tr_b16 v[166:167], v129 offset:49152
    ds_read_b64_tr_b16 v[168:169], v130 offset:47104
    ds_read_b64_tr_b16 v[170:171], v130 offset:49152
    ds_read_b64_tr_b16 v[172:173], v131 offset:47104
    ds_read_b64_tr_b16 v[174:175], v131 offset:49152
    s_mov_b32 s40, 0
recurrent_scan__ssm_conv_s4d__mixer_gmlp__prompt_kernel_s4mG_chk:
    s_waitcnt vmcnt(4)
    v_cmp_ne_u64 vcc, v[36:37], v[2:3]
    s_nop 1
    s_cbranch_vccnz recurrent_scan__ssm_conv_s4d__mixer_gmlp__prompt_kernel_s4mG_retry
recurrent_scan__ssm_conv_s4d__mixer_gmlp__prompt_kernel_s4mG_ok:
    s_add_u32 s7, s50, 0
    v_mfma_f32_16x16x32_bf16 v[112:115], v[192:195], v[68:71], v[112:115]
    ds_read_b64_tr_b16 v[176:177], v128 offset:8192
    buffer_load_dwordx4 v[88:91], v1, s[8:11], s7 offen offset:2048 sc1
    ds_read_b64_tr_b16 v[178:179], v128 offset:10240
    v_mfma_f32_16x16x32_bf16 v[116:119], v[196:199], v[68:71], v[116:119]
    s_add_u32 s7, s50, 4096
    ds_read_b64_tr_b16 v[180:181], v129 offset:8192
    ds_read_b64_tr_b16 v[182:183], v129 offset:10240
    v_mfma_f32_16x16x32_bf16 v[120:123], v[200:203], v[68:71], v[120:123]
    buffer_load_dwordx4 v[92:95], v1, s[8:11], s7 offen offset:2048 sc1
    ds_read_b64_tr_b16 v[184:185], v130 offset:8192
    ds_read_b64_tr_b16 v[186:187], v130 offset:10240
    s_add_u32 s7, s50, 8192
    v_mfma_f32_16x16x32_bf16 v[124:127], v[204:207], v[68:71], v[124:127]
    ds_read_b64_tr_b16 v[188:189], v131 offset:8192
    ds_read_b64_tr_b16 v[190:191], v131 offset:10240
    buffer_load_dwordx4 v[96:99], v1, s[8:11], s7 offen offset:2048 sc1
    s_waitcnt lgkmcnt(15)
    s_waitcnt vmcnt(6)
    v_mfma_f32_16x16x32_bf16 v[112:115], v[208:211], v[72:75], v[112:115]
    s_add_u32 s7, s50, 12288
    ds_read_b64_tr_b16 v[192:193], v128 offset:22528
    ds_read_b64_tr_b16 v[194:195], v128 offset:24576
    v_mfma_f32_16x16x32_bf16 v[116:119], v[212:215], v[72:75], v[116:119]
    buffer_load_dwordx4 v[100:103], v1, s[8:11], s7 offen offset:2048 sc1
    ds_read_b64_tr_b16 v[196:197], v129 offset:22528
    ds_read_b64_tr_b16 v[198:199], v129 offset:24576
    s_add_u32 s7, s50, 0
    v_mfma_f32_16x16x32_bf16 v[120:123], v[216:219], v[72:75], v[120:123]
    ds_read_b64_tr_b16 v[200:201], v130 offset:22528
    buffer_load_dwordx4 v[240:243], v1, s[8:11], s7 offen offset:3072 sc1
    ds_read_b64_tr_b16 v[202:203], v130 offset:24576
    v_mfma_f32_16x16x32_bf16 v[124:127], v[220:223], v[72:75], v[124:127]
    ds_read_b64_tr_b16 v[204:205], v131 offset:22528
    s_add_u32 s7, s50, 4096
    ds_read_b64_tr_b16 v[206:207], v131 offset:24576
    buffer_load_dwordx4 v[244:247], v1, s[8:11], s7 offen offset:3072 sc1
    s_waitcnt vmcnt(8)
    v_mfma_f32_16x16x32_bf16 v[112:115], v[224:227], v[76:79], v[112:115]
    ds_read_b64_tr_b16 v[208:209], v128 offset:36864
    ds_read_b64_tr_b16 v[210:211], v128 offset:38912
    s_add_u32 s7, s50, 8192
    v_mfma_f32_16x16x32_bf16 v[116:119], v[228:231], v[76:79], v[116:119]
    ds_read_b64_tr_b16 v[212:213], v129 offset:36864
    buffer_load_dwordx4 v[248:251], v1, s[8:11], s7 offen offset:3072 sc1
    ds_read_b64_tr_b16 v[214:215], v129 offset:38912
    v_mfma_f32_16x16x32_bf16 v[120:123], v[232:235], v[76:79], v[120:123]
    ds_read_b64_tr_b16 v[216:217], v130 offset:36864
    s_add_u32 s7, s50, 12288
    ds_read_b64_tr_b16 v[218:219], v130 offset:38912
    v_mfma_f32_16x16x32_bf16 v[124:127], v[236:239], v[76:79], v[124:127]
    buffer_load_dwordx4 v[252:255], v1, s[8:11], s7 offen offset:3072 sc1
    ds_read_b64_tr_b16 v[220:221], v131 offset:36864
    ds_read_b64_tr_b16 v[222:223], v131 offset:38912
    s_waitcnt vmcnt(9)
    v_mfma_f32_16x16x32_bf16 v[112:115], v[144:147], v[80:83], v[112:115]
    ds_read_b64_tr_b16 v[224:225], v128 offset:51200
    ds_read_b64_tr_b16 v[226:227], v128 offset:53248
    v_mfma_f32_16x16x32_bf16 v[116:119], v[148:151], v[80:83], v[116:119]
    ds_read_b64_tr_b16 v[228:229], v129 offset:51200
    ds_read_b64_tr_b16 v[230:231], v129 offset:53248
    v_mfma_f32_16x16x32_bf16 v[120:123], v[152:155], v[80:83], v[120:123]
    ds_read_b64_tr_b16 v[232:233], v130 offset:51200
    ds_read_b64_tr_b16 v[234:235], v130 offset:53248
    v_mfma_f32_16x16x32_bf16 v[124:127], v[156:159], v[80:83], v[124:127]
    ds_read_b64_tr_b16 v[236:237], v131 offset:51200
    ds_read_b64_tr_b16 v[238:239], v131 offset:53248
    s_waitcnt lgkmcnt(15)
    s_waitcnt vmcnt(8)
    v_mfma_f32_16x16x32_bf16 v[112:115], v[160:163], v[84:87], v[112:115]
    ds_read_b64_tr_b16 v[144:145], v128 offset:12288
    ds_read_b64_tr_b16 v[146:147], v128 offset:26624
    v_mfma_f32_16x16x32_bf16 v[116:119], v[164:167], v[84:87], v[116:119]
    ds_read_b64_tr_b16 v[148:149], v129 offset:12288
    ds_read_b64_tr_b16 v[150:151], v129 offset:26624
    v_mfma_f32_16x16x32_bf16 v[120:123], v[168:171], v[84:87], v[120:123]
    ds_read_b64_tr_b16 v[152:153], v130 offset:12288
    ds_read_b64_tr_b16 v[154:155], v130 offset:26624
    v_mfma_f32_16x16x32_bf16 v[124:127], v[172:175], v[84:87], v[124:127]
    ds_read_b64_tr_b16 v[156:157], v131 offset:12288
    ds_read_b64_tr_b16 v[158:159], v131 offset:26624
    s_waitcnt vmcnt(7)
    v_mfma_f32_16x16x32_bf16 v[112:115], v[176:179], v[88:91], v[112:115]
    ds_read_b64_tr_b16 v[160:161], v128 offset:40960
    ds_read_b64_tr_b16 v[162:163], v128 offset:55296
    v_mfma_f32_16x16x32_bf16 v[116:119], v[180:183], v[88:91], v[116:119]
    ds_read_b64_tr_b16 v[164:165], v129 offset:40960
    ds_read_b64_tr_b16 v[166:167], v129 offset:55296
    v_mfma_f32_16x16x32_bf16 v[120:123], v[184:187], v[88:91], v[120:123]
    ds_read_b64_tr_b16 v[168:169], v130 offset:40960
    ds_read_b64_tr_b16 v[170:171], v130 offset:55296
    v_mfma_f32_16x16x32_bf16 v[124:127], v[188:191], v[88:91], v[124:127]
    ds_read_b64_tr_b16 v[172:173], v131 offset:40960
    ds_read_b64_tr_b16 v[174:175], v131 offset:55296
    s_waitcnt vmcnt(6)
    v_mfma_f32_16x16x32_bf16 v[112:115], v[192:195], v[92:95], v[112:115]
    v_mfma_f32_16x16x32_bf16 v[116:119], v[196:199], v[92:95], v[116:119]
    v_mfma_f32_16x16x32_bf16 v[120:123], v[200:203], v[92:95], v[120:123]
    v_mfma_f32_16x16x32_bf16 v[124:127], v[204:207], v[92:95], v[124:127]
    s_waitcnt lgkmcnt(15)
    s_waitcnt vmcnt(5)
    v_mfma_f32_16x16x32_bf16 v[112:115], v[208:211], v[96:99], v[112:115]
    v_mfma_f32_16x16x32_bf16 v[116:119], v[212:215], v[96:99], v[116:119]
    v_mfma_f32_16x16x32_bf16 v[120:123], v[216:219], v[96:99], v[120:123]
    v_mfma_f32_16x16x32_bf16 v[124:127], v[220:223], v[96:99], v[124:127]
    s_waitcnt vmcnt(4)
    v_mfma_f32_16x16x32_bf16 v[112:115], v[224:227], v[100:103], v[112:115]
    v_mfma_f32_16x16x32_bf16 v[116:119], v[228:231], v[100:103], v[116:119]
    v_mfma_f32_16x16x32_bf16 v[120:123], v[232:235], v[100:103], v[120:123]
    v_mfma_f32_16x16x32_bf16 v[124:127], v[236:239], v[100:103], v[124:127]
    s_mov_b32 s40, 0
recurrent_scan__ssm_conv_s4d__mixer_gmlp__prompt_kernel_s4bG_chk:
    s_waitcnt vmcnt(0)
    v_xor_b32 v110, v253, v2
    v_xor_b32 v111, v255, v3
    v_xor_b32 v108, v249, v2
    v_xor_b32 v109, v251, v3
    v_xor_b32 v106, v245, v2
    v_xor_b32 v107, v247, v3
    v_xor_b32 v104, v241, v2
    v_xor_b32 v105, v243, v3
    v_or3_b32 v104, v104, v105, v106
    v_or3_b32 v107, v107, v108, v109
    v_or3_b32 v104, v104, v110, v111
    v_or_b32 v104, v104, v107
    v_cmp_ne_u32 vcc, 0, v104
    s_nop 1
    s_cbranch_vccnz recurrent_scan__ssm_conv_s4d__mixer_gmlp__prompt_kernel_s4bG_retry
recurrent_scan__ssm_conv_s4d__mixer_gmlp__prompt_kernel_s4bG_ok:
    v_mov_b32 v241, v242
    v_mov_b32 v242, v244
    v_mov_b32 v243, v246
    v_mov_b32 v249, v250
    v_mov_b32 v250, v252
    v_mov_b32_e64 v251, v254
    s_waitcnt lgkmcnt(14)
    v_mfma_f32_16x16x32_bf16 v[112:115], v[144:147], v[240:243], v[112:115]
    s_waitcnt lgkmcnt(12)
    v_mfma_f32_16x16x32_bf16 v[116:119], v[148:151], v[240:243], v[116:119]
    s_waitcnt lgkmcnt(10)
    v_mfma_f32_16x16x32_bf16 v[120:123], v[152:155], v[240:243], v[120:123]
    s_waitcnt lgkmcnt(8)
    v_mfma_f32_16x16x32_bf16 v[124:127], v[156:159], v[240:243], v[124:127]
    s_waitcnt lgkmcnt(6)
    v_mfma_f32_16x16x32_bf16 v[112:115], v[160:163], v[248:251], v[112:115]
    s_waitcnt lgkmcnt(4)
    v_mfma_f32_16x16x32_bf16 v[116:119], v[164:167], v[248:251], v[116:119]
    s_waitcnt lgkmcnt(2)
    v_mfma_f32_16x16x32_bf16 v[120:123], v[168:171], v[248:251], v[120:123]
    s_waitcnt lgkmcnt(0)
    v_mfma_f32_16x16x32_bf16 v[124:127], v[172:175], v[248:251], v[124:127]
    s_nop 1
    ds_write_b128 v138, v[112:115] offset:0
    s_nop 0
    ds_write_b128 v138, v[116:119] offset:1024
    s_nop 0
    ds_write_b128 v138, v[120:123] offset:2048
    s_nop 0
    ds_write_b128 v138, v[124:127] offset:3072
    s_waitcnt lgkmcnt(0)
    s_barrier
    s_endpgm
recurrent_scan__ssm_conv_s4d__mixer_gmlp__prompt_kernel_H2:
    s_sub_u32 s20, s20, 4096
    s_subb_u32 s21, s21, 0
    s_mov_b32 s22, 8392704
    s_mov_b32 s23, 0x20000
    s_mov_b32 s30, 2097152
    s_mov_b32 s31, 0x20000
    v_lshrrev_b32 v48, 1, v40
    v_xor_b32 v48, v48, v41
    v_lshlrev_b32 v48, 4, v48
    v_lshl_add_u32 v48, v40, 7, v48
    s_lshl_b32 s7, s3, 13
    s_add_u32 s62, s7, 114688
    v_add_u32 v20, s62, v48
    v_xor_b32 v21, 64, v20
    s_add_u32 s63, s7, 0
    v_add_u32 v22, s63, v48
    v_xor_b32 v23, 64, v22
    s_lshl_b32 s7, s5, 18
    s_lshl_b32 s32, s49, 9
    s_add_u32 s7, s7, s32
    v_lshlrev_b32 v35, 7, v43
    s_lshl_b32 s32, s59, 17
    s_add_u32 s64, s7, s32
    s_and_b32 s7, s48, 1
    s_lshl_b32 s65, s7, 8
    v_lshl_add_u32 v16, v42, 12, v46
    s_xor_b32 s7, s58, 0
    s_lshl_b32 s7, s7, 16
    s_add_u32 s7, s7, 4096
    v_add_u32 v16, s7, v16
    v_lshl_add_u32 v17, v42, 12, v47
    s_xor_b32 s7, s58, 0
    s_lshl_b32 s7, s7, 16
    s_add_u32 s7, s7, 35840
    v_add_u32 v17, s7, v17
    v_lshl_add_u32 v18, v42, 12, v46
    s_xor_b32 s7, s58, 1
    s_lshl_b32 s7, s7, 16
    s_add_u32 s7, s7, 2048
    v_add_u32 v18, s7, v18
    v_lshl_add_u32 v19, v42, 12, v47
    s_xor_b32 s7, s58, 1
    s_lshl_b32 s7, s7, 16
    s_add_u32 s7, s7, 33792
    v_add_u32_e64 v19, s7, v19
    s_xor_b32 s7, s65, 0
    v_lshl_add_u32 v26, s7, 4, v1
    s_xor_b32 s7, s65, 128
    v_lshl_add_u32 v27, s7, 4, v1
    s_xor_b32 s7, s65, 256
    v_lshl_add_u32 v28, s7, 4, v1
    s_xor_b32 s7, s65, 384
    v_lshl_add_u32 v29, s7, 4, v1
    s_xor_b32 s7, s3, 0
    s_mul_i32 s7, s7, 7168
    s_add_u32 s7, s7, 52224
    v_add_u32 v30, s7, v1
    s_xor_b32 s7, s3, 1
    s_mul_i32 s7, s7, 7168
    s_add_u32 s7, s7, 53248
    v_add_u32 v31, s7, v1
    s_xor_b32 s7, s3, 2
    s_mul_i32 s7, s7, 7168
    s_add_u32 s7, s7, 54272
    v_add_u32_e64 v32, s7, v1
    s_xor_b32 s7, s3, 3
    s_mul_i32 s7, s7, 7168
    s_add_u32 s7, s7, 55296
    v_add_u32 v33, s7, v1
    s_add_u32 s7, s33, 149504
    v_lshl_add_u32 v48, v40, 7, v46
    v_add_u32 v65, s7, v48
    v_add_u32 v66, s7, v1
    v_add_u32 v48, 0, v0
    s_mul_i32 s50, s3, 7168
    v_mul_u32_u24 v49, 4682, v48
    v_lshrrev_b32 v49, 16, v49
    v_mul_u32_u24 v46, 14, v49
    s_xor_b32 s7, s4, 1
    v_sub_u32 v48, v48, v46
    v_lshrrev_b32 v46, 1, v49
    v_xor_b32 v46, v46, v49
    v_bfe_u32 v46, v46, 2, 1
    s_mul_i32 s7, s7, 224
    v_mul_u32_u24 v46, 12, v46
    v_xor_b32 v49, v49, v46
    v_mul_u32_u24 v49, 3584, v49
    v_lshl_add_u32 v56, v48, 4, v49
    s_add_u32 s7, s7, 1792
    v_add_u32 v48, 64, v0
    v_mul_u32_u24 v49, 4682, v48
    v_lshrrev_b32 v49, 16, v49
    v_mul_u32_u24 v46, 14, v49
    s_mul_i32 s56, s4, 224
    v_sub_u32 v48, v48, v46
    v_lshrrev_b32 v46, 1, v49
    v_xor_b32 v46, v46, v49
    v_bfe_u32 v46, v46, 2, 1
    s_sub_u32 s56, s7, s56
    v_mul_u32_u24 v46, 12, v46
    v_xor_b32 v49, v49, v46
    v_mul_u32_u24 v49, 3584, v49
    v_lshl_add_u32 v57, v48, 4, v49
    s_lshl1_add_u32 s32, s6, s3
    v_subrev_u32 v57, 1024, v57
    v_add_u32 v48, 128, v0
    v_mul_u32_u24 v49, 4682, v48
    v_lshrrev_b32 v49, 16, v49
    s_add_u32 s52, s32, 0
    v_mul_u32_u24 v46, 14, v49
    v_sub_u32 v48, v48, v46
    v_lshrrev_b32 v46, 1, v49
    s_and_b32 s52, s52, 15
    v_xor_b32 v46, v46, v49
    v_bfe_u32 v46, v46, 2, 1
    v_mul_u32_u24 v46, 12, v46
    v_xor_b32_e64 v49, v49, v46
    s_mul_i32 s52, s52, 114688
    v_mul_u32_u24 v49, 3584, v49
    v_lshl_add_u32 v58, v48, 4, v49
    v_subrev_u32 v58, 2048, v58
    v_add_u32 v48, 192, v0
    s_add_u32 s52, s52, s7
    v_mul_u32_u24 v49, 4682, v48
    v_lshrrev_b32 v49, 16, v49
    v_mul_u32_u24 v46, 14, v49
    v_sub_u32 v48, v48, v46
    s_add_u32 s53, s32, 4
    v_lshrrev_b32 v46, 1, v49
    v_xor_b32 v46, v46, v49
    v_bfe_u32 v46, v46, 2, 1
    v_mul_u32_u24 v46, 12, v46
    s_and_b32 s53, s53, 15
    v_xor_b32 v49, v49, v46
    v_mul_u32_u24 v49, 3584, v49
    v_lshl_add_u32 v59, v48, 4, v49
    v_subrev_u32 v59, 3072, v59
    s_mul_i32 s53, s53, 114688
    v_add_u32 v48, 256, v0
    v_mul_u32_u24 v49, 4682, v48
    v_lshrrev_b32 v49, 16, v49
    v_mul_u32_u24 v46, 14, v49
    s_add_u32 s53, s53, s7
    v_sub_u32 v48, v48, v46
    v_lshrrev_b32 v46, 1, v49
    v_xor_b32 v46, v46, v49
    v_bfe_u32 v46, v46, 2, 1
    s_add_u32 s54, s32, 8
    v_mul_u32_u24 v46, 12, v46
    v_xor_b32 v49, v49, v46
    v_mul_u32_u24 v49, 3584, v49
    s_and_b32 s54, s54, 15
    v_lshl_add_u32 v60, v48, 4, v49
    v_add_u32 v48, 320, v0
    v_mul_u32_u24 v49, 4682, v48
    v_lshrrev_b32 v49, 16, v49
    s_mul_i32 s54, s54, 114688
    v_mul_u32_u24 v46, 14, v49
    v_sub_u32 v48, v48, v46
    v_lshrrev_b32 v46, 1, v49
    v_xor_b32 v46, v46, v49
    s_add_u32 s54, s54, s7
    v_bfe_u32 v46, v46, 2, 1
    v_mul_u32_u24 v46, 12, v46
    v_xor_b32_e64 v49, v49, v46
    v_mul_u32_u24 v49, 3584, v49
    s_add_u32 s55, s32, 12
    v_lshl_add_u32 v61, v48, 4, v49
    v_subrev_u32 v61, 1024, v61
    v_add_u32 v48, 384, v0
    v_mul_u32_u24 v49, 4682, v48
    s_and_b32 s55, s55, 15
    v_lshrrev_b32 v49, 16, v49
    v_mul_u32_u24 v46, 14, v49
    v_sub_u32 v48, v48, v46
    v_lshrrev_b32 v46, 1, v49
    s_mul_i32 s55, s55, 114688
    v_xor_b32 v46, v46, v49
    v_bfe_u32 v46, v46, 2, 1
    v_mul_u32_u24 v46, 12, v46
    v_xor_b32 v49, v49, v46
    s_add_u32 s55, s55, s7
    v_mul_u32_u24 v49, 3584, v49
    v_lshl_add_u32 v62, v48, 4, v49
    v_subrev_u32 v62, 2048, v62
    v_and_b32 v46, 1, v41
    v_lshrrev_b32 v47, 5, v0
    v_lshl_add_u32 v48, v46, 3, v44
    v_lshlrev_b32 v48, 7, v48
    v_lshl_add_u32 v48, v47, 12, v48
    v_lshrrev_b32 v49, 1, v45
    s_lshl_b32 s32, s3, 1
    v_add_u32 v49, s32, v49
    v_xor_b32 v49, v49, v44
    v_lshl_add_u32 v48, v49, 4, v48
    v_and_b32 v49, 1, v0
    v_lshl_add_u32 v48, v49, 3, v48
    v_add_u32 v63, 147456, v48
    v_xor_b32 v64, 64, v63
    v_xor_b32 v48, v42, v43
    v_lshlrev_b32 v48, 4, v48
    v_lshl_add_u32 v67, v42, 12, v48
    s_add_u32 s7, s33, 147456
    v_bfe_u32 v48, v0, 1, 2
    v_lshl_add_u32 v48, v0, 2, v48
    v_lshl_add_u32 v68, v48, 4, s7
    v_bfe_u32 v48, v0, 3, 1
    v_lshl_add_u32 v48, v47, 1, v48
    v_lshrrev_b32_e64 v69, 1, v45
    v_lshl_add_u32 v69, v46, 1, v69
    v_xor_b32 v48, v48, v69
    v_lshl_add_u32 v69, v47, 2, v44
    v_lshl_add_u32 v48, v69, 2, v48
    v_lshl_add_u32 v48, v48, 4, s7
    v_lshl_add_u32 v69, v49, 3, v48
    v_xor_b32 v50, 16, v68
    v_xor_b32 v51, 32, v68
    v_xor_b32 v52, 48, v68
    v_add_u32_e64 v13, s63, v1
    v_xor_b32 v14, 0x2000, v13
    s_xor_b32 s7, s63, 0x2000
    v_lshl_add_u32 v15, v40, 5, s7
    v_lshl_add_u32 v15, v41, 3, v15
    s_mul_i32 s61, s59, 114688
    s_sub_u32 s61, 147456, s61
    s_mul_i32 s7, s58, 4160
    s_add_u32 s7, s7, s61
    v_add_u32 v71, s7, v1
    s_xor_b32 s32, s58, 1
    s_mul_i32 s32, s32, 4160
    s_add_u32 s32, s32, s61
    v_add_u32 v70, s32, v1
    s_sub_u32 s34, s32, s33
    s_sub_u32 s34, s34, 147456
    v_lshl_add_u32 v73, v43, 2, s7
    s_add_u32 s7, s7, 1008
    v_sub_u32_e64 v72, s7, v1
    s_lshl_b32 s32, s58, 8
    s_sub_u32 s32, s61, s32
    s_add_u32 s7, s32, 8784
    v_lshlrev_b32 v48, 4, v41
    v_lshl_add_u32 v8, v40, 5, s7
    v_sub_u32 v8, v8, v48
    s_add_u32 s7, s32, 7568
    v_mul_u32_u24 v49, 4164, v49
    v_sub_u32 v49, s7, v49
    v_sub_u32 v49, v49, v48
    v_and_b32 v48, 14, v0
    v_lshlrev_b32 v48, 1, v48
    v_sub_u32_e64 v9, v49, v48
    v_subrev_u32 v10, 1024, v9
    v_subrev_u32 v11, 2048, v9
    v_subrev_u32 v12, 3072, v9
    s_add_u32 s61, s61, 8448
    v_and_b32 v48, 6, v42
    v_xor_b32 v48, v48, v43
    v_lshlrev_b32_e64 v48, 4, v48
    v_lshl_add_u32 v4, v42, 10, v48
    v_add_u32 v5, 7168, v4
    v_add_u32 v6, 14336, v4
    v_add_u32 v7, 21504, v4
    v_or_b32 v34, s3, v0
    v_lshlrev_b32_e64 v34, 25, v34
    s_waitcnt vmcnt(0)
    s_add_u32 m0, s50, 0
    s_nop 0
    buffer_load_dwordx4 v56, s[16:19], s52 offen offset:0 lds
    buffer_load_dwordx4 v57, s[16:19], s52 offen offset:1024 lds
    buffer_load_dwordx4 v58, s[16:19], s52 offen offset:2048 lds
    buffer_load_dwordx4 v59, s[16:19], s52 offen offset:3072 lds
    s_add_u32 m0, s50, 4096
    s_nop 0
    buffer_load_dwordx4 v60, s[16:19], s52 offen offset:0 lds
    buffer_load_dwordx4 v61, s[16:19], s52 offen offset:1024 lds
    buffer_load_dwordx4 v62, s[16:19], s52 offen offset:2048 lds
    s_lshl2_add_u32 s7, s2, s3
    s_lshr_b32 s32, s7, 1
    s_lshl1_add_u32 s32, s32, s7
    s_mul_i32 s7, s7, 896
    s_mul_i32 s32, s32, 896
    s_mov_b64 exec, 0x7f
    buffer_load_dword v108, v97, s[16:19], s32 offen
    buffer_load_dword v110, v97, s[24:27], s7 offen
    s_mov_b64 exec, -1
    s_add_u32 m0, s50, 28672
    s_nop 0
    buffer_load_dwordx4 v56, s[16:19], s53 offen offset:0 lds
    buffer_load_dwordx4 v57, s[16:19], s53 offen offset:1024 lds
    buffer_load_dwordx4 v58, s[16:19], s53 offen offset:2048 lds
    buffer_load_dwordx4 v59, s[16:19], s53 offen offset:3072 lds
    s_add_u32 m0, s50, 32768
    s_nop 0
    buffer_load_dwordx4 v60, s[16:19], s53 offen offset:0 lds
    buffer_load_dwordx4 v61, s[16:19], s53 offen offset:1024 lds
    buffer_load_dwordx4 v62, s[16:19], s53 offen offset:2048 lds
    s_setprio 3
    s_waitcnt vmcnt(9)
    s_barrier
    ds_read_b64_tr_b16 v[112:113], v63 offset:0
    s_add_u32 m0, s50, 57344
    ds_read_b64_tr_b16 v[114:115], v64 offset:512
    ds_read_b64_tr_b16 v[116:117], v63 offset:8192
    ds_read_b64_tr_b16 v[118:119], v64 offset:8704
    s_lshl2_add_u32 s42, s6, s3
    s_lshl_b32 s42, s42, 16
    buffer_load_dwordx4 v56, s[16:19], s54 offen offset:0 lds
    s_lshl_b32 s32, s5, 7
    s_add_u32 s42, s42, s32
    s_add_u32 s42, s42, 12582912
    s_add_u32 s43, s42, 32768
    s_waitcnt lgkmcnt(2)
    ds_write_b128 v65, v[112:115]
    v_xor_b32_e64 v65, 64, v65
    buffer_load_dwordx4 v57, s[16:19], s54 offen offset:1024 lds
    s_waitcnt lgkmcnt(1)
    ds_write_b128 v65, v[116:119]
    ds_read_b128 v[120:123], v66 offset:0
    ds_read_b128 v[124:127], v66 offset:1024
    s_lshl_b32 s41, s6, 12
    s_add_u32 s41, s41, s32
    s_add_u32 s41, s41, 17170432
    buffer_load_dwordx4 v58, s[16:19], s54 offen offset:2048 lds
    v_add_u32 v2, 1, v2
    v_xor_b32 v3, 0x9e3779b9, v2
    v_lshlrev_b32 v96, 16, v96
    v_lshlrev_b32 v92, 16, v92
    v_lshlrev_b32 v93, 16, v93
    v_lshlrev_b32_e64 v94, 16, v94
    buffer_load_dwordx4 v59, s[16:19], s54 offen offset:3072 lds
    v_lshlrev_b32 v95, 16, v95
    v_lshlrev_b32 v74, 16, v74
    v_mul_f32 v96, 0x3fb8aa3b, v96
    v_mul_f32 v92, 0x3fb8aa3b, v92
    v_exp_f32 v96, v96
    v_exp_f32 v92, v92
    s_add_u32 m0, s50, 61440
    v_cvt_pk_bf16_f32 v96, v96, v96
    v_and_b32 v96, 0xffff0000, v96
    v_cvt_pk_bf16_f32 v92, v92, v92
    v_and_b32 v92, 0xffff0000, v92
    v_mul_f32 v92, v92, v96
    v_mul_f32 v93, v93, v96
    buffer_load_dwordx4 v60, s[16:19], s54 offen offset:0 lds
    v_add_f32 v96, v96, v96
    v_mul_f32 v93, 0.15915494, v93
    v_mul_f32 v84, v94, v96
    v_mul_f32 v85, v95, v96
    v_mul_f32_e64 v98, 0x3f800000, v93
    v_mul_f32 v99, 0xbfb8aa3b, v92
    buffer_load_dwordx4 v61, s[16:19], s54 offen offset:1024 lds
    v_mul_f32 v100, 0x41000000, v93
    v_mul_f32 v101, 0xc138aa3b, v92
    v_mul_f32 v102, 0x42800000, v93
    v_mul_f32 v103, 0xc2b8aa3b, v92
    v_mul_f32 v104, 0x43800000, v93
    v_mul_f32 v105, 0xc3b8aa3b, v92
    buffer_load_dwordx4 v62, s[16:19], s54 offen offset:2048 lds
    v_fract_f32 v98, v98
    v_fract_f32 v100, v100
    v_fract_f32 v102, v102
    v_fract_f32 v104, v104
    v_exp_f32 v99, v99
    s_waitcnt lgkmcnt(1)
    buffer_store_dwordx4 v[120:123], v67, s[8:11], s42 offen sc1
    s_waitcnt lgkmcnt(0)
    buffer_store_dwordx4 v[124:127], v67, s[8:11], s43 offen sc1
    s_waitcnt vmcnt(9)
    s_barrier
    v_cos_f32 v76, v98
    s_add_u32 m0, s50, 86016
    v_sin_f32 v77, v98
    v_exp_f32 v101, v101
    v_cos_f32 v78, v100
    v_sin_f32 v79, v100
    v_exp_f32 v103, v103
    v_cos_f32 v80, v102
    buffer_load_dwordx4 v56, s[16:19], s55 offen offset:0 lds
    v_sin_f32 v81, v102
    v_exp_f32 v105, v105
    v_cos_f32 v82, v104
    v_sin_f32 v83, v104
    v_mul_f32 v76, v76, v99
    v_mul_f32 v77, v77, v99
    v_mul_f32_e64 v78, v78, v101
    buffer_load_dwordx4 v57, s[16:19], s55 offen offset:1024 lds
    v_mul_f32 v79, v79, v101
    v_mul_f32 v80, v80, v103
    v_mul_f32 v81, v81, v103
    v_mul_f32 v82, v82, v105
    v_mul_f32 v83, v83, v105
    v_mul_f32 v182, v76, v76
    buffer_load_dwordx4 v58, s[16:19], s55 offen offset:2048 lds
    v_mul_f32 v183, v76, v77
    v_fma_f32 v182, -v77, v77, v182
    v_fmac_f32 v183, v77, v76
    v_mul_f32 v184, v182, v182
    v_mul_f32 v185, v182, v183
    v_fma_f32 v184, -v183, v183, v184
    v_fmac_f32 v185, v183, v182
    buffer_load_dwordx4 v59, s[16:19], s55 offen offset:3072 lds
    v_mul_f32 v186, v184, v182
    v_mul_f32 v187, v184, v183
    v_fma_f32 v186, -v185, v183, v186
    v_fmac_f32 v187, v185, v182
    v_mul_f32 v128, v84, v76
    v_mul_f32 v129, v84, v77
    s_add_u32 m0, s50, 90112
    v_fma_f32 v128, -v85, v77, v128
    v_fmac_f32 v129, v85, v76
    v_mul_f32 v130, v84, v182
    v_mul_f32 v131, v84, v183
    v_fma_f32 v130, -v85, v183, v130
    v_fmac_f32 v131, v85, v182
    v_mul_f32 v132, v128, v182
    buffer_load_dwordx4 v60, s[16:19], s55 offen offset:0 lds
    v_mul_f32 v133, v128, v183
    v_fma_f32 v132, -v129, v183, v132
    v_fmac_f32 v133, v129, v182
    v_mul_f32 v134, v84, v78
    v_mul_f32_e64 v135, v84, v79
    v_fma_f32 v134, -v85, v79, v134
    buffer_load_dwordx4 v61, s[16:19], s55 offen offset:1024 lds
    v_fmac_f32 v135, v85, v78
    v_mul_f32 v136, v84, v184
    v_mul_f32 v137, v84, v185
    v_fma_f32 v136, -v85, v185, v136
    v_fmac_f32 v137, v85, v184
    v_mul_f32 v138, v128, v184
    v_mul_f32 v139, v128, v185
    buffer_load_dwordx4 v62, s[16:19], s55 offen offset:2048 lds
    v_fma_f32 v138, -v129, v185, v138
    v_fmac_f32 v139, v129, v184
    v_mul_f32 v140, v130, v184
    v_mul_f32 v141, v130, v185
    v_fma_f32 v140, -v131, v185, v140
    v_fmac_f32 v141, v131, v184
    s_waitcnt vmcnt(9)
    s_barrier
    v_mul_f32 v142, v132, v184
    s_sub_u32 s52, s52, s56
    v_mul_f32 v143, v132, v185
    v_fma_f32 v142, -v133, v185, v142
    v_fmac_f32 v143, v133, v184
    v_mul_f32 v144, v84, v82
    v_mul_f32 v145, v84, v83
    v_fma_f32 v144, -v85, v83, v144
    s_add_u32 m0, s50, 0
    v_fmac_f32 v145, v85, v82
    v_mul_f32 v146, v144, v82
    v_mul_f32 v147, v144, v83
    v_fma_f32 v146, -v145, v83, v146
    v_fmac_f32 v147, v145, v82
    v_mul_f32 v148, v146, v82
    buffer_load_dwordx4 v56, s[16:19], s52 offen offset:0 lds
    v_mul_f32 v149, v146, v83
    v_fma_f32 v148, -v147, v83, v148
    v_fmac_f32 v149, v147, v82
    v_mul_f32 v150, v148, v82
    v_mul_f32 v151, v148, v83
    v_fma_f32 v150, -v149, v83, v150
    buffer_load_dwordx4 v57, s[16:19], s52 offen offset:1024 lds
    v_fmac_f32 v151, v149, v82
    v_mul_f32 v152, v150, v82
    v_mul_f32 v153, v150, v83
    v_fma_f32 v152, -v151, v83, v152
    v_fmac_f32 v153, v151, v82
    v_mul_f32 v154, v152, v82
    buffer_load_dwordx4 v58, s[16:19], s52 offen offset:2048 lds
    v_mul_f32 v155, v152, v83
    v_fma_f32 v154, -v153, v83, v154
    v_fmac_f32 v155, v153, v82
    v_mul_f32 v156, v154, v82
    v_mul_f32 v157, v154, v83
    v_fma_f32 v156, -v155, v83, v156
    buffer_load_dwordx4 v59, s[16:19], s52 offen offset:3072 lds
    v_fmac_f32 v157, v155, v82
    v_mul_f32 v158, v144, v182
    v_mul_f32 v159, v144, v183
    v_fma_f32 v158, -v145, v183, v158
    v_fmac_f32 v159, v145, v182
    v_mul_f32 v160, v144, v184
    s_add_u32 m0, s50, 4096
    v_mul_f32 v161, v144, v185
    v_fma_f32 v160, -v145, v185, v160
    v_fmac_f32 v161, v145, v184
    v_mul_f32 v162, v144, v186
    v_mul_f32 v163, v144, v187
    v_fma_f32 v162, -v145, v187, v162
    buffer_load_dwordx4 v60, s[16:19], s52 offen offset:0 lds
    v_fmac_f32 v163, v145, v186
    v_mul_f32 v164, v144, v78
    v_mul_f32_e64 v165, v144, v79
    v_fma_f32 v164, -v145, v79, v164
    v_fmac_f32 v165, v145, v78
    v_mul_f32 v166, v146, v184
    buffer_load_dwordx4 v61, s[16:19], s52 offen offset:1024 lds
    v_mul_f32 v167, v146, v185
    v_fma_f32 v166, -v147, v185, v166
    v_fmac_f32 v167, v147, v184
    v_mul_f32 v168, v146, v78
    v_mul_f32 v169, v146, v79
    v_fma_f32 v168, -v147, v79, v168
    buffer_load_dwordx4 v62, s[16:19], s52 offen offset:2048 lds
    v_fmac_f32 v169, v147, v78
    v_mul_f32 v170, v148, v184
    v_mul_f32 v171, v148, v185
    v_fma_f32 v170, -v149, v185, v170
    v_fmac_f32 v171, v149, v184
    s_waitcnt vmcnt(7)
    s_barrier
    buffer_store_dwordx2 v[2:3], v34, s[8:11], s41 offen sc1
    v_mul_f32 v172, v148, v78
    s_sub_u32 s53, s53, s56
    v_mul_f32 v173, v148, v79
    v_fma_f32 v172, -v149, v79, v172
    v_fmac_f32 v173, v149, v78
    v_mul_f32 v174, v150, v78
    v_mul_f32 v175, v150, v79
    s_add_u32 m0, s50, 28672
    v_fma_f32 v174, -v151, v79, v174
    v_fmac_f32 v175, v151, v78
    v_mul_f32 v176, v152, v78
    v_mul_f32 v177, v152, v79
    v_fma_f32 v176, -v153, v79, v176
    buffer_load_dwordx4 v56, s[16:19], s53 offen offset:0 lds
    v_fmac_f32 v177, v153, v78
    v_mul_f32 v178, v154, v78
    v_mul_f32 v179, v154, v79
    v_fma_f32 v178, -v155, v79, v178
    v_fmac_f32 v179, v155, v78
    buffer_load_dwordx4 v57, s[16:19], s53 offen offset:1024 lds
    v_mul_f32 v180, v156, v78
    v_mul_f32 v181, v156, v79
    v_fma_f32 v180, -v157, v79, v180
    v_fmac_f32 v181, v157, v78
    v_cvt_pk_bf16_f32 v192, v84, v128
    buffer_load_dwordx4 v58, s[16:19], s53 offen offset:2048 lds
    v_cvt_pk_bf16_f32 v193, v130, v132
    v_cvt_pk_bf16_f32 v194, v144, v144
    v_cvt_pk_bf16_f32 v195, v158, v160
    v_cvt_pk_bf16_f32 v208, v85, v129
    v_cvt_pk_bf16_f32 v209, v131, v133
    v_cvt_pk_bf16_f32 v210, v145, v145
    buffer_load_dwordx4 v59, s[16:19], s53 offen offset:3072 lds
    v_cvt_pk_bf16_f32 v211, v159, v161
    v_cvt_pk_bf16_f32 v196, v136, v138
    v_cvt_pk_bf16_f32 v197, v140, v142
    v_cvt_pk_bf16_f32 v198, v160, v160
    v_cvt_pk_bf16_f32 v199, v162, v164
    s_add_u32 m0, s50, 32768
    v_cvt_pk_bf16_f32 v212, v137, v139
    v_cvt_pk_bf16_f32 v213, v141, v143
    v_cvt_pk_bf16_f32 v214, v161, v161
    v_cvt_pk_bf16_f32 v215, v163, v165
    v_cvt_pk_bf16_f32 v200, v134, v146
    buffer_load_dwordx4 v60, s[16:19], s53 offen offset:0 lds
    v_cvt_pk_bf16_f32 v201, v166, v168
    v_cvt_pk_bf16_f32 v202, v164, v148
    v_cvt_pk_bf16_f32 v203, v170, v172
    v_cvt_pk_bf16_f32 v216, v135, v147
    v_cvt_pk_bf16_f32 v217, v167, v169
    buffer_load_dwordx4 v61, s[16:19], s53 offen offset:1024 lds
    v_cvt_pk_bf16_f32 v218, v165, v149
    v_cvt_pk_bf16_f32 v219, v171, v173
    v_cvt_pk_bf16_f32 v204, v150, v174
    v_cvt_pk_bf16_f32 v205, v154, v178
    v_cvt_pk_bf16_f32 v206, v152, v176
    buffer_load_dwordx4 v62, s[16:19], s53 offen offset:2048 lds
    v_cvt_pk_bf16_f32 v207, v156, v180
    v_cvt_pk_bf16_f32 v220, v151, v175
    v_cvt_pk_bf16_f32 v221, v155, v179
    v_cvt_pk_bf16_f32 v222, v153, v177
    v_cvt_pk_bf16_f32 v223, v157, v181
    s_barrier
    s_add_u32 s7, s65, s64
    s_xor_b32 s7, s7, 0
    s_add_u32 m0, s62, 0
    s_nop 0
    buffer_load_dwordx4 v16, s[20:23], s7 offen offset:0 lds
    buffer_load_dwordx4 v17, s[20:23], s7 offen offset:1024 lds
    buffer_load_dwordx4 v18, s[20:23], s7 offen offset:2048 lds
    buffer_load_dwordx4 v19, s[20:23], s7 offen offset:3072 lds
    ds_write_b128 v68, v[192:195]
    ds_write_b128 v50, v[196:199]
    ds_write_b128 v51, v[200:203]
    ds_write_b128 v52, v[204:207]
    ds_read_b64_tr_b16 v[88:89], v69 offset:0
    ds_read_b64_tr_b16 v[92:93], v69 offset:512
    ds_read_b64_tr_b16 v[96:97], v69 offset:1024
    ds_read_b64_tr_b16 v[100:101], v69 offset:1536
    ds_read_b64_tr_b16 v[104:105], v69 offset:2048
    ds_read_b64_tr_b16 v[108:109], v69 offset:2560
    ds_read_b64_tr_b16 v[112:113], v69 offset:3072
    ds_read_b64_tr_b16 v[116:117], v69 offset:3584
    s_add_u32 m0, s62, 4096
    s_xor_b32 s7, s7, 0x20000
    buffer_load_dwordx4 v16, s[20:23], s7 offen offset:0 lds
    buffer_load_dwordx4 v17, s[20:23], s7 offen offset:1024 lds
    buffer_load_dwordx4 v18, s[20:23], s7 offen offset:2048 lds
    buffer_load_dwordx4 v19, s[20:23], s7 offen offset:3072 lds
    ds_write_b128 v68, v[208:211]
    ds_write_b128 v50, v[212:215]
    ds_write_b128 v51, v[216:219]
    ds_write_b128 v52, v[220:223]
    ds_read_b64_tr_b16 v[90:91], v69 offset:0
    ds_read_b64_tr_b16 v[94:95], v69 offset:512
    ds_read_b64_tr_b16 v[98:99], v69 offset:1024
    ds_read_b64_tr_b16 v[102:103], v69 offset:1536
    ds_read_b64_tr_b16 v[106:107], v69 offset:2048
    ds_read_b64_tr_b16 v[110:111], v69 offset:2560
    ds_read_b64_tr_b16 v[114:115], v69 offset:3072
    ds_read_b64_tr_b16 v[118:119], v69 offset:3584
    s_lshl2_add_u32 s41, s4, s3
    s_lshl_b32 s41, s41, 10
    s_add_u32 s41, s41, 17170432
    s_waitcnt vmcnt(16)
    s_barrier
    v_add_u32 v68, s34, v68
    s_sub_u32 s54, s54, s56
    v_add_u32 v50, s34, v50
    v_add_u32 v51, s34, v51
    v_add_u32 v52, s34, v52
    v_add_u32 v69, s34, v69
    s_add_u32 m0, s50, 57344
    v_mul_f32 v192, v80, v80
    v_mul_f32_e64 v193, v80, v81
    v_fma_f32 v192, -v81, v81, v192
    v_fmac_f32 v193, v81, v80
    v_mul_f32 v208, v192, v80
    buffer_load_dwordx4 v56, s[16:19], s54 offen offset:0 lds
    v_mul_f32 v209, v192, v81
    v_fma_f32 v208, -v193, v81, v208
    v_fmac_f32 v209, v193, v80
    v_mul_f32 v164, v78, v78
    buffer_load_dwordx4 v57, s[16:19], s54 offen offset:1024 lds
    v_mul_f32 v165, v78, v79
    v_fma_f32 v164, -v79, v79, v164
    v_fmac_f32 v165, v79, v78
    v_mul_f32 v166, v164, v78
    v_mul_f32 v167, v164, v79
    buffer_load_dwordx4 v58, s[16:19], s54 offen offset:2048 lds
    v_fma_f32 v166, -v165, v79, v166
    v_fmac_f32 v167, v165, v78
    v_mul_f32 v168, v166, v78
    v_mul_f32 v169, v166, v79
    buffer_load_dwordx4 v59, s[16:19], s54 offen offset:3072 lds
    v_fma_f32 v168, -v167, v79, v168
    v_fmac_f32 v169, v167, v78
    v_mul_f32 v170, v168, v78
    v_mul_f32 v171, v168, v79
    v_fma_f32 v170, -v169, v79, v170
    s_add_u32 m0, s50, 61440
    v_fmac_f32 v171, v169, v78
    v_mul_f32 v172, v170, v78
    v_mul_f32 v173, v170, v79
    v_fma_f32 v172, -v171, v79, v172
    buffer_load_dwordx4 v60, s[16:19], s54 offen offset:0 lds
    v_fmac_f32 v173, v171, v78
    v_mul_f32 v174, v172, v78
    v_mul_f32_e64 v175, v172, v79
    v_fma_f32 v174, -v173, v79, v174
    v_fmac_f32 v175, v173, v78
    buffer_load_dwordx4 v61, s[16:19], s54 offen offset:1024 lds
    v_mul_f32 v178, v80, v78
    v_mul_f32 v179, v80, v79
    v_fma_f32 v178, -v81, v79, v178
    v_fmac_f32 v179, v81, v78
    buffer_load_dwordx4 v62, s[16:19], s54 offen offset:2048 lds
    v_mul_f32 v180, v178, v78
    v_mul_f32 v181, v178, v79
    v_fma_f32 v180, -v179, v79, v180
    v_fmac_f32 v181, v179, v78
    v_mul_f32 v182, v180, v78
    buffer_load_dwordx2 v[36:37], v35, s[8:11], s41 offen sc1
    v_mul_f32 v183, v180, v79
    v_fma_f32 v182, -v181, v79, v182
    v_fmac_f32 v183, v181, v78
    v_mul_f32 v184, v182, v78
    s_waitcnt vmcnt(16)
    s_barrier
    s_waitcnt vmcnt(8)
    ds_read_b128 v[128:131], v20 offset:0
    ds_read_b128 v[132:135], v20 offset:2048
    ds_read_b128 v[136:139], v20 offset:4096
    ds_read_b128 v[140:143], v20 offset:6144
    ds_read_b128 v[144:147], v21 offset:0
    ds_read_b128 v[148:151], v21 offset:2048
    ds_read_b128 v[152:155], v21 offset:4096
    ds_read_b128 v[156:159], v21 offset:6144
    v_mul_f32 v185, v182, v79
    s_sub_u32 s55, s55, s56
    v_fma_f32 v184, -v183, v79, v184
    v_fmac_f32 v185, v183, v78
    v_mul_f32 v186, v184, v78
    v_mul_f32 v187, v184, v79
    s_add_u32 m0, s50, 86016
    v_fma_f32 v186, -v185, v79, v186
    v_fmac_f32 v187, v185, v78
    v_mul_f32 v188, v186, v78
    v_mul_f32 v189, v186, v79
    buffer_load_dwordx4 v56, s[16:19], s55 offen offset:0 lds
    v_fma_f32 v188, -v187, v79, v188
    v_fmac_f32 v189, v187, v78
    v_mul_f32 v190, v188, v78
    v_mul_f32 v191, v188, v79
    v_fma_f32 v190, -v189, v79, v190
    buffer_load_dwordx4 v57, s[16:19], s55 offen offset:1024 lds
    v_fmac_f32 v191, v189, v78
    v_mul_f32 v194, v192, v78
    v_mul_f32 v195, v192, v79
    v_fma_f32 v194, -v193, v79, v194
    buffer_load_dwordx4 v58, s[16:19], s55 offen offset:2048 lds
    v_fmac_f32 v195, v193, v78
    v_mul_f32 v196, v194, v78
    v_mul_f32_e64 v197, v194, v79
    v_fma_f32 v196, -v195, v79, v196
    v_fmac_f32 v197, v195, v78
    buffer_load_dwordx4 v59, s[16:19], s55 offen offset:3072 lds
    v_mul_f32 v198, v196, v78
    v_mul_f32 v199, v196, v79
    v_fma_f32 v198, -v197, v79, v198
    v_fmac_f32 v199, v197, v78
    s_add_u32 m0, s50, 90112
    v_mul_f32 v200, v198, v78
    v_mul_f32 v201, v198, v79
    v_fma_f32 v200, -v199, v79, v200
    v_fmac_f32 v201, v199, v78
    buffer_load_dwordx4 v60, s[16:19], s55 offen offset:0 lds
    v_mul_f32 v202, v200, v78
    v_mul_f32 v203, v200, v79
    v_fma_f32 v202, -v201, v79, v202
    v_fmac_f32 v203, v201, v78
    v_mul_f32 v204, v202, v78
    buffer_load_dwordx4 v61, s[16:19], s55 offen offset:1024 lds
    v_mul_f32 v205, v202, v79
    v_fma_f32 v204, -v203, v79, v204
    v_fmac_f32 v205, v203, v78
    v_mul_f32 v206, v204, v78
    buffer_load_dwordx4 v62, s[16:19], s55 offen offset:2048 lds
    v_mul_f32 v207, v204, v79
    v_fma_f32 v206, -v205, v79, v206
    v_fmac_f32 v207, v205, v78
    v_mul_f32 v210, v208, v78
    s_waitcnt vmcnt(8)
    s_barrier
    s_mov_b32 s40, 0
recurrent_scan__ssm_conv_s4d__mixer_gmlp__prompt_kernel_sx_chk:
    s_waitcnt vmcnt(7)
    v_cmp_ne_u64 vcc, v[36:37], v[2:3]
    s_nop 1
    s_cbranch_vccnz recurrent_scan__ssm_conv_s4d__mixer_gmlp__prompt_kernel_sx_retry
recurrent_scan__ssm_conv_s4d__mixer_gmlp__prompt_kernel_sx_ok:
    v_mul_f32 v211, v208, v79
    s_lshl1_add_u32 s35, s57, s58
    v_fma_f32 v210, -v209, v79, v210
    v_fmac_f32 v211, v209, v78
    s_lshl_b32 s35, s35, 11
    v_mul_f32 v212, v210, v78
    v_mul_f32 v213, v210, v79
    s_add_u32 s35, s35, 14680064
    v_fma_f32 v212, -v211, v79, v212
    v_fmac_f32 v213, v211, v78
    s_waitcnt lgkmcnt(0)
    v_mul_f32 v214, v212, v78
    v_mul_f32_e64 v215, v212, v79
    s_add_u32 s7, s65, s64
    v_fma_f32 v214, -v213, v79, v214
    v_fmac_f32 v215, v213, v78
    s_xor_b32 s7, s7, 128
    v_mul_f32 v216, v214, v78
    v_mul_f32 v217, v214, v79
    s_add_u32 m0, s62, 0
    v_fma_f32 v216, -v215, v79, v216
    v_fmac_f32 v217, v215, v78
    buffer_load_dwordx4 v16, s[20:23], s7 offen offset:0 lds
    v_mul_f32 v218, v216, v78
    v_mul_f32_e64 v219, v216, v79
    buffer_load_dwordx4 v17, s[20:23], s7 offen offset:1024 lds
    v_fma_f32 v218, -v217, v79, v218
    v_fmac_f32 v219, v217, v78
    buffer_load_dwordx4 v18, s[20:23], s7 offen offset:2048 lds
    v_mul_f32 v220, v218, v78
    v_mul_f32 v221, v218, v79
    buffer_load_dwordx4 v19, s[20:23], s7 offen offset:3072 lds
    v_fma_f32 v220, -v219, v79, v220
    v_fmac_f32 v221, v219, v78
    s_add_u32 m0, s62, 4096
    v_mul_f32 v222, v220, v78
    v_mul_f32 v223, v220, v79
    s_xor_b32 s7, s7, 0x20000
    v_fma_f32 v222, -v221, v79, v222
    v_fmac_f32_e64 v223, v221, v78
    buffer_load_dwordx4 v16, s[20:23], s7 offen offset:0 lds
    v_cvt_pk_bf16_f32 v224, 1.0, v78
    v_cvt_pk_bf16_f32 v225, v164, v166
    buffer_load_dwordx4 v17, s[20:23], s7 offen offset:1024 lds
    v_cvt_pk_bf16_f32 v226, v168, v170
    v_cvt_pk_bf16_f32 v227, v172, v174
    buffer_load_dwordx4 v18, s[20:23], s7 offen offset:2048 lds
    v_cvt_pk_bf16_f32 v240, 0, -v79
    v_cvt_pk_bf16_f32 v241, -v165, -v167
    buffer_load_dwordx4 v19, s[20:23], s7 offen offset:3072 lds
    v_cvt_pk_bf16_f32 v242, -v169, -v171
    v_cvt_pk_bf16_f32 v243, -v173, -v175
    s_lshl_b32 s56, s3, 15
    v_cvt_pk_bf16_f32 v228, v80, v178
    v_cvt_pk_bf16_f32 v229, v180, v182
    s_lshl_b32 s7, s4, 7
    v_cvt_pk_bf16_f32 v230, v184, v186
    v_cvt_pk_bf16_f32 v231, v188, v190
    s_add_u32 s56, s56, s7
    v_cvt_pk_bf16_f32 v244, -v81, -v179
    v_cvt_pk_bf16_f32 v245, -v181, -v183
    s_mul_i32 s7, s4, 465920
    v_cvt_pk_bf16_f32 v246, -v185, -v187
    v_cvt_pk_bf16_f32 v247, -v189, -v191
    s_lshl_b32 s32, s49, 13
    v_cvt_pk_bf16_f32 v232, v192, v194
    v_cvt_pk_bf16_f32 v233, v196, v198
    s_add_u32 s42, s7, s32
    v_cvt_pk_bf16_f32 v234, v200, v202
    v_cvt_pk_bf16_f32 v235, v204, v206
    s_add_u32 s43, s42, 66560
    v_cvt_pk_bf16_f32 v248, -v193, -v195
    v_cvt_pk_bf16_f32 v249, -v197, -v199
    s_add_u32 s44, s42, 133120
    v_cvt_pk_bf16_f32 v250, -v201, -v203
    v_cvt_pk_bf16_f32 v251, -v205, -v207
    s_add_u32 s45, s42, 199680
    v_cvt_pk_bf16_f32 v236, v208, v210
    v_cvt_pk_bf16_f32 v237, v212, v214
    s_add_u32 s46, s42, 266240
    v_cvt_pk_bf16_f32 v238, v216, v218
    v_cvt_pk_bf16_f32 v239, v220, v222
    s_add_u32 s47, s42, 332800
    v_cvt_pk_bf16_f32 v252, -v209, -v211
    v_cvt_pk_bf16_f32 v253, -v213, -v215
    s_add_u32 s48, s42, 399360
    v_cvt_pk_bf16_f32 v254, -v217, -v219
    v_cvt_pk_bf16_f32 v255, -v221, -v223
    s_waitcnt vmcnt(8)
    s_barrier
    s_setprio 1
    ds_write_b128 v68, v[224:227]
    ds_write_b128 v50, v[228:231]
    ds_write_b128 v51, v[232:235]
    ds_write_b128 v52, v[236:239]
    ds_read_b64_tr_b16 v[192:193], v69 offset:0
    ds_read_b64_tr_b16 v[196:197], v69 offset:512
    ds_read_b64_tr_b16 v[200:201], v69 offset:1024
    ds_read_b64_tr_b16 v[204:205], v69 offset:1536
    ds_read_b64_tr_b16 v[208:209], v69 offset:2048
    ds_read_b64_tr_b16 v[212:213], v69 offset:2560
    ds_read_b64_tr_b16 v[216:217], v69 offset:3072
    ds_read_b64_tr_b16 v[220:221], v69 offset:3584
    ds_write_b128 v68, v[240:243]
    ds_write_b128 v50, v[244:247]
    ds_write_b128 v51, v[248:251]
    ds_write_b128 v52, v[252:255]
    ds_read_b64_tr_b16 v[194:195], v69 offset:0
    ds_read_b64_tr_b16 v[198:199], v69 offset:512
    ds_read_b64_tr_b16 v[202:203], v69 offset:1024
    ds_read_b64_tr_b16 v[206:207], v69 offset:1536
    ds_read_b64_tr_b16 v[210:211], v69 offset:2048
    ds_read_b64_tr_b16 v[214:215], v69 offset:2560
    ds_read_b64_tr_b16 v[218:219], v69 offset:3072
    ds_read_b64_tr_b16 v[222:223], v69 offset:3584
    s_waitcnt lgkmcnt(7)
    v_mfma_f32_32x32x16_bf16 v[224:239], v[88:91], v[192:195], 0
    s_waitcnt lgkmcnt(6)
    v_mfma_f32_32x32x16_bf16 v[224:239], v[92:95], v[196:199], v[224:239]
    s_waitcnt lgkmcnt(5)
    v_mfma_f32_32x32x16_bf16 v[224:239], v[96:99], v[200:203], v[224:239]
    s_waitcnt lgkmcnt(4)
    v_mfma_f32_32x32x16_bf16 v[224:239], v[100:103], v[204:207], v[224:239]
    s_waitcnt lgkmcnt(3)
    v_mfma_f32_32x32x16_bf16 v[224:239], v[104:107], v[208:211], v[224:239]
    s_waitcnt lgkmcnt(2)
    v_mfma_f32_32x32x16_bf16 v[224:239], v[108:111], v[212:215], v[224:239]
    s_waitcnt lgkmcnt(1)
    v_mfma_f32_32x32x16_bf16 v[224:239], v[112:115], v[216:219], v[224:239]
    s_waitcnt lgkmcnt(0)
    v_mfma_f32_32x32x16_bf16 v[224:239], v[116:119], v[220:223], v[224:239]
    s_nop 11
    ds_write_b128 v70, v[224:227] offset:0
    ds_write_b128 v70, v[228:231] offset:1024
    ds_write_b128 v70, v[232:235] offset:2048
    ds_write_b128 v70, v[236:239] offset:3072
    s_setprio 3
    s_waitcnt lgkmcnt(0)
    s_barrier
    ds_read_b128 v[240:243], v71 offset:0
    ds_read_b128 v[244:247], v71 offset:1024
    ds_read_b128 v[248:251], v71 offset:2048
    ds_read_b128 v[252:255], v71 offset:3072
    s_and_b32 s7, s57, -2
    s_lshl2_add_u32 s7, s7, s3
    s_lshl_b32 s7, s7, 10
    s_lshl_b32 s32, s3, 10
    s_add_u32 m0, s32, 156416
    s_add_u32 s7, s7, 12582912
    buffer_load_dwordx4 v1, s[8:11], s7 offen sc1 lds
    s_add_u32 m0, s32, 41728
    s_add_u32 s7, s7, 4096
    buffer_load_dwordx4 v1, s[8:11], s7 offen sc1 lds
    s_xor_b32 s32, s4, 1
    s_lshl_b32 s32, s32, 5
    s_add_u32 s32, s32, s5
    s_lshl_b32 s32, s32, 7
    s_add_u32 s32, s32, 17498112
    s_sub_u32 s52, 0, s58
    s_mov_b32 s53, s52
    s_mov_b32 s38, 0xaaaaaaaa
    s_mov_b32 s39, 0xaaaaaaaa
    s_and_b64 s[54:55], s[52:53], s[38:39]
    s_or_b64 s[36:37], s[52:53], s[38:39]
    v_cmp_eq_u32 vcc, 0, v0
    v_and_b32 v46, 31, v0
    v_lshl_add_u32 v46, v46, 4, s61
    v_cndmask_b32 v74, 0, v74, vcc
    v_add_f32 v224, v224, v74
    s_waitcnt lgkmcnt(3)
    v_add_f32 v224, v224, v240
    v_add_f32 v225, v225, v241
    v_add_f32 v226, v226, v242
    v_add_f32 v227, v227, v243
    s_waitcnt lgkmcnt(2)
    v_add_f32 v228, v228, v244
    v_add_f32 v229, v229, v245
    v_add_f32 v230, v230, v246
    v_add_f32 v231, v231, v247
    s_waitcnt lgkmcnt(1)
    v_add_f32 v232, v232, v248
    v_add_f32 v233, v233, v249
    v_add_f32 v234, v234, v250
    v_add_f32 v235, v235, v251
    s_waitcnt lgkmcnt(0)
    v_add_f32 v236, v236, v252
    v_add_f32 v237, v237, v253
    v_add_f32 v238, v238, v254
    v_add_f32 v239, v239, v255
    v_mov_b32 v240, 0
    v_mov_b32 v241, 0
    v_mov_b32 v242, 0
    v_mov_b32 v243, 0
    v_cvt_pk_bf16_f32 v206, v224, 0
    s_and_b64 s[38:39], s[52:53], 1
    v_cndmask_b32 v206, 0, v206, s[38:39]
    v_cndmask_b32 v192, v224, v225, s[52:53]
    v_cndmask_b32 v193, v225, v226, s[52:53]
    v_cndmask_b32 v194, v226, v227, s[52:53]
    v_cndmask_b32 v195, v227, v228, s[52:53]
    v_cndmask_b32 v196, v228, v229, s[52:53]
    v_cndmask_b32 v197, v229, v230, s[52:53]
    v_cndmask_b32 v198, v230, v231, s[52:53]
    v_cndmask_b32 v199, v231, v232, s[52:53]
    v_cndmask_b32 v200, v233, v234, s[52:53]
    v_cndmask_b32 v201, v234, v235, s[52:53]
    v_cndmask_b32 v202, v236, v237, s[54:55]
    v_cndmask_b32 v203, v236, v237, s[36:37]
    v_cndmask_b32 v204, v238, v239, s[54:55]
    v_cndmask_b32 v205, v238, v239, s[36:37]
    v_cvt_pk_bf16_f32 v208, v199, v198
    v_cvt_pk_bf16_f32 v209, v197, v196
    v_cvt_pk_bf16_f32 v210, v195, v194
    v_cvt_pk_bf16_f32 v211, v193, v192
    v_cvt_pk_bf16_f32 v212, v235, v235
    v_cvt_pk_bf16_f32 v213, v201, v234
    v_cvt_pk_bf16_f32 v214, v234, v200
    v_cvt_pk_bf16_f32 v215, v233, v233
    s_barrier
    buffer_store_dwordx2 v[2:3], v34, s[8:11], s32 offen sc1
    v_cvt_pk_bf16_f32 v216, v237, v237
    v_cvt_pk_bf16_f32 v217, v237, v203
    v_cvt_pk_bf16_f32 v218, v202, v236
    v_cvt_pk_bf16_f32 v219, v236, v236
    v_cvt_pk_bf16_f32 v220, v239, v239
    v_cvt_pk_bf16_f32 v221, v239, v205
    v_cvt_pk_bf16_f32 v222, v204, v238
    v_cvt_pk_bf16_f32 v223, v238, v238
    ds_write_b128 v72, v[208:211] offset:3072
    ds_write_b128 v72, v[212:215] offset:2048
    ds_write_b128 v72, v[216:219] offset:1024
    ds_write_b128 v72, v[220:223] offset:0
    ds_write_b128 v46, v[240:243]
    s_mov_b64 exec, 0xff
    ds_write_b32 v73, v206 offset:4096
    s_mov_b64 exec, -1
    s_waitcnt vmcnt(3)
    ds_read_b128 v[160:163], v20 offset:0
    ds_read_b128 v[164:167], v20 offset:2048
    ds_read_b128 v[168:171], v20 offset:4096
    ds_read_b128 v[172:175], v20 offset:6144
    ds_read_b128 v[176:179], v21 offset:0
    ds_read_b128 v[180:183], v21 offset:2048
    ds_read_b128 v[184:187], v21 offset:4096
    ds_read_b128 v[188:191], v21 offset:6144
    s_mul_i32 s50, s51, 33792
    s_add_u32 s50, s50, 4194304
    s_lshl_b32 s54, s51, 14
    s_lshl_b32 s7, s4, 7
    s_add_u32 s54, s54, s7
    s_lshl2_add_u32 s55, s59, s58
    s_lshl_b32 s55, s55, 11
    s_add_u32 s55, s55, 4096
    s_mov_b32 s61, 0xffff0000
    s_lshl2_add_u32 s41, s4, s3
    s_lshl_b32 s41, s41, 10
    s_add_u32 s41, s41, 17203200
    s_waitcnt vmcnt(1) lgkmcnt(0)
    s_barrier
    s_setprio 1
    ds_read_b128 v[224:227], v8 offset:192
    ds_read2_b32 v[220:221], v12 offset0:48 offset1:49
    ds_read2_b32 v[222:223], v12 offset0:50 offset1:51
    ds_read_b128 v[228:231], v8 offset:704
    ds_read2_b32 v[216:217], v12 offset0:176 offset1:177
    ds_read2_b32 v[218:219], v12 offset0:178 offset1:179
    ds_read_b128 v[232:235], v8 offset:1216
    ds_read2_b32 v[212:213], v11 offset0:48 offset1:49
    ds_read2_b32 v[214:215], v11 offset0:50 offset1:51
    ds_read_b128 v[236:239], v8 offset:1728
    ds_read2_b32 v[208:209], v11 offset0:176 offset1:177
    ds_read2_b32 v[210:211], v11 offset0:178 offset1:179
    ds_read_b128 v[240:243], v8 offset:2240
    ds_read2_b32 v[204:205], v10 offset0:48 offset1:49
    ds_read2_b32 v[206:207], v10 offset0:50 offset1:51
    ds_read_b128 v[244:247], v8 offset:2752
    ds_read2_b32 v[200:201], v10 offset0:176 offset1:177
    ds_read2_b32 v[202:203], v10 offset0:178 offset1:179
    ds_read_b128 v[248:251], v8 offset:3264
    ds_read2_b32 v[196:197], v9 offset0:48 offset1:49
    ds_read2_b32 v[198:199], v9 offset0:50 offset1:51
    ds_read_b128 v[252:255], v8 offset:3776
    ds_read2_b32 v[192:193], v9 offset0:176 offset1:177
    ds_read2_b32 v[194:195], v9 offset0:178 offset1:179
    s_waitcnt lgkmcnt(15)
    v_mfma_f32_16x16x32_bf16 v[116:119], v[220:223], v[224:227], 0
    ds_read2_b32 v[220:221], v12 offset0:32 offset1:33
    v_mfma_f32_16x16x32_bf16 v[112:115], v[216:219], v[224:227], 0
    ds_read2_b32 v[222:223], v12 offset0:34 offset1:35
    v_mfma_f32_16x16x32_bf16 v[116:119], v[216:219], v[228:231], v[116:119]
    ds_read2_b32 v[216:217], v12 offset0:160 offset1:161
    v_mfma_f32_16x16x32_bf16 v[108:111], v[212:215], v[224:227], 0
    ds_read2_b32 v[218:219], v12 offset0:162 offset1:163
    v_mfma_f32_16x16x32_bf16 v[112:115], v[212:215], v[228:231], v[112:115]
    v_mfma_f32_16x16x32_bf16 v[116:119], v[212:215], v[232:235], v[116:119]
    ds_read2_b32 v[212:213], v11 offset0:32 offset1:33
    s_waitcnt lgkmcnt(15)
    v_mfma_f32_16x16x32_bf16 v[104:107], v[208:211], v[224:227], 0
    ds_read2_b32 v[214:215], v11 offset0:34 offset1:35
    v_mfma_f32_16x16x32_bf16 v[108:111], v[208:211], v[228:231], v[108:111]
    v_mfma_f32_16x16x32_bf16 v[112:115], v[208:211], v[232:235], v[112:115]
    v_mfma_f32_16x16x32_bf16 v[116:119], v[208:211], v[236:239], v[116:119]
    ds_read2_b32 v[208:209], v11 offset0:160 offset1:161
    s_waitcnt lgkmcnt(15)
    v_mfma_f32_16x16x32_bf16 v[100:103], v[204:207], v[224:227], 0
    ds_read2_b32 v[210:211], v11 offset0:162 offset1:163
    v_mfma_f32_16x16x32_bf16 v[104:107], v[204:207], v[228:231], v[104:107]
    v_mfma_f32_16x16x32_bf16 v[108:111], v[204:207], v[232:235], v[108:111]
    v_mfma_f32_16x16x32_bf16 v[112:115], v[204:207], v[236:239], v[112:115]
    v_mfma_f32_16x16x32_bf16 v[116:119], v[204:207], v[240:243], v[116:119]
    ds_read2_b32 v[204:205], v10 offset0:32 offset1:33
    s_waitcnt lgkmcnt(15)
    v_mfma_f32_16x16x32_bf16 v[96:99], v[200:203], v[224:227], 0
    ds_read2_b32 v[206:207], v10 offset0:34 offset1:35
    v_mfma_f32_16x16x32_bf16 v[100:103], v[200:203], v[228:231], v[100:103]
    v_mfma_f32_16x16x32_bf16 v[104:107], v[200:203], v[232:235], v[104:107]
    v_mfma_f32_16x16x32_bf16 v[108:111], v[200:203], v[236:239], v[108:111]
    v_mfma_f32_16x16x32_bf16 v[112:115], v[200:203], v[240:243], v[112:115]
    v_mfma_f32_16x16x32_bf16 v[116:119], v[200:203], v[244:247], v[116:119]
    ds_read2_b32 v[200:201], v10 offset0:160 offset1:161
    s_waitcnt lgkmcnt(14)
    v_mfma_f32_16x16x32_bf16 v[92:95], v[196:199], v[224:227], 0
    ds_read2_b32 v[202:203], v10 offset0:162 offset1:163
    v_mfma_f32_16x16x32_bf16 v[96:99], v[196:199], v[228:231], v[96:99]
    v_mfma_f32_16x16x32_bf16 v[100:103], v[196:199], v[232:235], v[100:103]
    v_mfma_f32_16x16x32_bf16 v[104:107], v[196:199], v[236:239], v[104:107]
    v_mfma_f32_16x16x32_bf16 v[108:111], v[196:199], v[240:243], v[108:111]
    v_mfma_f32_16x16x32_bf16 v[112:115], v[196:199], v[244:247], v[112:115]
    v_mfma_f32_16x16x32_bf16 v[116:119], v[196:199], v[248:251], v[116:119]
    ds_read2_b32 v[196:197], v9 offset0:32 offset1:33
    s_waitcnt lgkmcnt(13)
    v_mfma_f32_16x16x32_bf16 v[88:91], v[192:195], v[224:227], 0
    ds_read2_b32 v[198:199], v9 offset0:34 offset1:35
    ds_read_b128 v[224:227], v8 offset:128
    v_mfma_f32_16x16x32_bf16 v[92:95], v[192:195], v[228:231], v[92:95]
    ds_read_b128 v[228:231], v8 offset:640
    v_mfma_f32_16x16x32_bf16 v[96:99], v[192:195], v[232:235], v[96:99]
    ds_read_b128 v[232:235], v8 offset:1152
    v_mfma_f32_16x16x32_bf16 v[100:103], v[192:195], v[236:239], v[100:103]
    ds_read_b128 v[236:239], v8 offset:1664
    v_mfma_f32_16x16x32_bf16 v[104:107], v[192:195], v[240:243], v[104:107]
    ds_read_b128 v[240:243], v8 offset:2176
    v_mfma_f32_16x16x32_bf16 v[108:111], v[192:195], v[244:247], v[108:111]
    ds_read_b128 v[244:247], v8 offset:2688
    v_mfma_f32_16x16x32_bf16 v[112:115], v[192:195], v[248:251], v[112:115]
    ds_read_b128 v[248:251], v8 offset:3200
    v_mfma_f32_16x16x32_bf16 v[116:119], v[192:195], v[252:255], v[116:119]
    ds_read_b128 v[252:255], v8 offset:3712
    s_waitcnt lgkmcnt(7)
    v_mfma_f32_16x16x32_bf16 v[116:119], v[220:223], v[224:227], v[116:119]
    ds_read2_b32 v[192:193], v9 offset0:160 offset1:161
    v_mfma_f32_16x16x32_bf16 v[112:115], v[216:219], v[224:227], v[112:115]
    ds_read2_b32 v[194:195], v9 offset0:162 offset1:163
    s_waitcnt lgkmcnt(8)
    v_mfma_f32_16x16x32_bf16 v[116:119], v[216:219], v[228:231], v[116:119]
    ds_read2_b32 v[220:221], v12 offset0:16 offset1:17
    v_mfma_f32_16x16x32_bf16 v[108:111], v[212:215], v[224:227], v[108:111]
    ds_read2_b32 v[222:223], v12 offset0:18 offset1:19
    v_mfma_f32_16x16x32_bf16 v[112:115], v[212:215], v[228:231], v[112:115]
    ds_read2_b32 v[216:217], v12 offset0:144 offset1:145
    s_waitcnt lgkmcnt(10)
    v_mfma_f32_16x16x32_bf16 v[116:119], v[212:215], v[232:235], v[116:119]
    ds_read2_b32 v[218:219], v12 offset0:146 offset1:147
    v_mfma_f32_16x16x32_bf16 v[104:107], v[208:211], v[224:227], v[104:107]
    ds_read2_b32 v[212:213], v11 offset0:16 offset1:17
    v_mfma_f32_16x16x32_bf16 v[108:111], v[208:211], v[228:231], v[108:111]
    ds_read2_b32 v[214:215], v11 offset0:18 offset1:19
    v_mfma_f32_16x16x32_bf16 v[112:115], v[208:211], v[232:235], v[112:115]
    s_waitcnt lgkmcnt(12)
    v_mfma_f32_16x16x32_bf16 v[116:119], v[208:211], v[236:239], v[116:119]
    ds_read2_b32 v[208:209], v11 offset0:144 offset1:145
    v_mfma_f32_16x16x32_bf16 v[100:103], v[204:207], v[224:227], v[100:103]
    ds_read2_b32 v[210:211], v11 offset0:146 offset1:147
    v_mfma_f32_16x16x32_bf16 v[104:107], v[204:207], v[228:231], v[104:107]
    v_mfma_f32_16x16x32_bf16 v[108:111], v[204:207], v[232:235], v[108:111]
    v_mfma_f32_16x16x32_bf16 v[112:115], v[204:207], v[236:239], v[112:115]
    s_waitcnt lgkmcnt(13)
    v_mfma_f32_16x16x32_bf16 v[116:119], v[204:207], v[240:243], v[116:119]
    ds_read2_b32 v[204:205], v10 offset0:16 offset1:17
    v_mfma_f32_16x16x32_bf16 v[96:99], v[200:203], v[224:227], v[96:99]
    ds_read2_b32 v[206:207], v10 offset0:18 offset1:19
    v_mfma_f32_16x16x32_bf16 v[100:103], v[200:203], v[228:231], v[100:103]
    v_mfma_f32_16x16x32_bf16 v[104:107], v[200:203], v[232:235], v[104:107]
    v_mfma_f32_16x16x32_bf16 v[108:111], v[200:203], v[236:239], v[108:111]
    v_mfma_f32_16x16x32_bf16 v[112:115], v[200:203], v[240:243], v[112:115]
    s_waitcnt lgkmcnt(14)
    v_mfma_f32_16x16x32_bf16 v[116:119], v[200:203], v[244:247], v[116:119]
    ds_read2_b32 v[200:201], v10 offset0:144 offset1:145
    v_mfma_f32_16x16x32_bf16 v[92:95], v[196:199], v[224:227], v[92:95]
    ds_read2_b32 v[202:203], v10 offset0:146 offset1:147
    v_mfma_f32_16x16x32_bf16 v[96:99], v[196:199], v[228:231], v[96:99]
    v_mfma_f32_16x16x32_bf16 v[100:103], v[196:199], v[232:235], v[100:103]
    v_mfma_f32_16x16x32_bf16 v[104:107], v[196:199], v[236:239], v[104:107]
    v_mfma_f32_16x16x32_bf16 v[108:111], v[196:199], v[240:243], v[108:111]
    v_mfma_f32_16x16x32_bf16 v[112:115], v[196:199], v[244:247], v[112:115]
    s_waitcnt lgkmcnt(15)
    v_mfma_f32_16x16x32_bf16 v[116:119], v[196:199], v[248:251], v[116:119]
    ds_read2_b32 v[196:197], v9 offset0:16 offset1:17
    s_waitcnt lgkmcnt(13)
    v_mfma_f32_16x16x32_bf16 v[88:91], v[192:195], v[224:227], v[88:91]
    ds_read2_b32 v[198:199], v9 offset0:18 offset1:19
    ds_read_b128 v[224:227], v8 offset:64
    v_mfma_f32_16x16x32_bf16 v[92:95], v[192:195], v[228:231], v[92:95]
    ds_read_b128 v[228:231], v8 offset:576
    v_mfma_f32_16x16x32_bf16 v[96:99], v[192:195], v[232:235], v[96:99]
    ds_read_b128 v[232:235], v8 offset:1088
    v_mfma_f32_16x16x32_bf16 v[100:103], v[192:195], v[236:239], v[100:103]
    ds_read_b128 v[236:239], v8 offset:1600
    v_mfma_f32_16x16x32_bf16 v[104:107], v[192:195], v[240:243], v[104:107]
    ds_read_b128 v[240:243], v8 offset:2112
    v_mfma_f32_16x16x32_bf16 v[108:111], v[192:195], v[244:247], v[108:111]
    ds_read_b128 v[244:247], v8 offset:2624
    v_mfma_f32_16x16x32_bf16 v[112:115], v[192:195], v[248:251], v[112:115]
    ds_read_b128 v[248:251], v8 offset:3136
    v_mfma_f32_16x16x32_bf16 v[116:119], v[192:195], v[252:255], v[116:119]
    ds_read_b128 v[252:255], v8 offset:3648
    s_waitcnt lgkmcnt(7)
    v_mfma_f32_16x16x32_bf16 v[116:119], v[220:223], v[224:227], v[116:119]
    ds_read2_b32 v[192:193], v9 offset0:144 offset1:145
    v_mfma_f32_16x16x32_bf16 v[112:115], v[216:219], v[224:227], v[112:115]
    ds_read2_b32 v[194:195], v9 offset0:146 offset1:147
    s_waitcnt lgkmcnt(8)
    v_mfma_f32_16x16x32_bf16 v[116:119], v[216:219], v[228:231], v[116:119]
    ds_read2_b32 v[220:221], v12 offset0:0 offset1:1
    v_mfma_f32_16x16x32_bf16 v[108:111], v[212:215], v[224:227], v[108:111]
    ds_read2_b32 v[222:223], v12 offset0:2 offset1:3
    v_mfma_f32_16x16x32_bf16 v[112:115], v[212:215], v[228:231], v[112:115]
    ds_read2_b32 v[216:217], v12 offset0:128 offset1:129
    s_waitcnt lgkmcnt(10)
    v_mfma_f32_16x16x32_bf16 v[116:119], v[212:215], v[232:235], v[116:119]
    ds_read2_b32 v[218:219], v12 offset0:130 offset1:131
    v_mfma_f32_16x16x32_bf16 v[104:107], v[208:211], v[224:227], v[104:107]
    ds_read2_b32 v[212:213], v11 offset0:0 offset1:1
    v_mfma_f32_16x16x32_bf16 v[108:111], v[208:211], v[228:231], v[108:111]
    ds_read2_b32 v[214:215], v11 offset0:2 offset1:3
    v_mfma_f32_16x16x32_bf16 v[112:115], v[208:211], v[232:235], v[112:115]
    s_waitcnt lgkmcnt(12)
    v_mfma_f32_16x16x32_bf16 v[116:119], v[208:211], v[236:239], v[116:119]
    ds_read2_b32 v[208:209], v11 offset0:128 offset1:129
    v_mfma_f32_16x16x32_bf16 v[100:103], v[204:207], v[224:227], v[100:103]
    ds_read2_b32 v[210:211], v11 offset0:130 offset1:131
    v_mfma_f32_16x16x32_bf16 v[104:107], v[204:207], v[228:231], v[104:107]
    v_mfma_f32_16x16x32_bf16 v[108:111], v[204:207], v[232:235], v[108:111]
    v_mfma_f32_16x16x32_bf16 v[112:115], v[204:207], v[236:239], v[112:115]
    s_waitcnt lgkmcnt(13)
    v_mfma_f32_16x16x32_bf16 v[116:119], v[204:207], v[240:243], v[116:119]
    ds_read2_b32 v[204:205], v10 offset0:0 offset1:1
    v_mfma_f32_16x16x32_bf16 v[96:99], v[200:203], v[224:227], v[96:99]
    ds_read2_b32 v[206:207], v10 offset0:2 offset1:3
    v_mfma_f32_16x16x32_bf16 v[100:103], v[200:203], v[228:231], v[100:103]
    v_mfma_f32_16x16x32_bf16 v[104:107], v[200:203], v[232:235], v[104:107]
    v_mfma_f32_16x16x32_bf16 v[108:111], v[200:203], v[236:239], v[108:111]
    v_mfma_f32_16x16x32_bf16 v[112:115], v[200:203], v[240:243], v[112:115]
    s_waitcnt lgkmcnt(14)
    v_mfma_f32_16x16x32_bf16 v[116:119], v[200:203], v[244:247], v[116:119]
    ds_read2_b32 v[200:201], v10 offset0:128 offset1:129
    v_mfma_f32_16x16x32_bf16 v[92:95], v[196:199], v[224:227], v[92:95]
    ds_read2_b32 v[202:203], v10 offset0:130 offset1:131
    v_mfma_f32_16x16x32_bf16 v[96:99], v[196:199], v[228:231], v[96:99]
    v_mfma_f32_16x16x32_bf16 v[100:103], v[196:199], v[232:235], v[100:103]
    v_mfma_f32_16x16x32_bf16 v[104:107], v[196:199], v[236:239], v[104:107]
    v_mfma_f32_16x16x32_bf16 v[108:111], v[196:199], v[240:243], v[108:111]
    v_mfma_f32_16x16x32_bf16 v[112:115], v[196:199], v[244:247], v[112:115]
    s_waitcnt lgkmcnt(15)
    v_mfma_f32_16x16x32_bf16 v[116:119], v[196:199], v[248:251], v[116:119]
    ds_read2_b32 v[196:197], v9 offset0:0 offset1:1
    s_waitcnt lgkmcnt(13)
    v_mfma_f32_16x16x32_bf16 v[88:91], v[192:195], v[224:227], v[88:91]
    ds_read2_b32 v[198:199], v9 offset0:2 offset1:3
    ds_read_b128 v[224:227], v8 offset:0
    v_mfma_f32_16x16x32_bf16 v[92:95], v[192:195], v[228:231], v[92:95]
    ds_read_b128 v[228:231], v8 offset:512
    v_mfma_f32_16x16x32_bf16 v[96:99], v[192:195], v[232:235], v[96:99]
    ds_read_b128 v[232:235], v8 offset:1024
    v_mfma_f32_16x16x32_bf16 v[100:103], v[192:195], v[236:239], v[100:103]
    ds_read_b128 v[236:239], v8 offset:1536
    v_mfma_f32_16x16x32_bf16 v[104:107], v[192:195], v[240:243], v[104:107]
    ds_read_b128 v[240:243], v8 offset:2048
    v_mfma_f32_16x16x32_bf16 v[108:111], v[192:195], v[244:247], v[108:111]
    ds_read_b128 v[244:247], v8 offset:2560
    v_mfma_f32_16x16x32_bf16 v[112:115], v[192:195], v[248:251], v[112:115]
    ds_read_b128 v[248:251], v8 offset:3072
    v_mfma_f32_16x16x32_bf16 v[116:119], v[192:195], v[252:255], v[116:119]
    ds_read_b128 v[252:255], v8 offset:3584
    s_waitcnt lgkmcnt(7)
    v_mfma_f32_16x16x32_bf16 v[116:119], v[220:223], v[224:227], v[116:119]
    ds_read2_b32 v[192:193], v9 offset0:128 offset1:129
    v_mfma_f32_16x16x32_bf16 v[112:115], v[216:219], v[224:227], v[112:115]
    ds_read2_b32 v[194:195], v9 offset0:130 offset1:131
    s_waitcnt lgkmcnt(8)
    v_mfma_f32_16x16x32_bf16 v[116:119], v[216:219], v[228:231], v[116:119]
    v_mfma_f32_16x16x32_bf16 v[108:111], v[212:215], v[224:227], v[108:111]
    v_mfma_f32_16x16x32_bf16 v[112:115], v[212:215], v[228:231], v[112:115]
    s_waitcnt lgkmcnt(7)
    v_mfma_f32_16x16x32_bf16 v[116:119], v[212:215], v[232:235], v[116:119]
    v_mfma_f32_16x16x32_bf16 v[104:107], v[208:211], v[224:227], v[104:107]
    v_mfma_f32_16x16x32_bf16 v[108:111], v[208:211], v[228:231], v[108:111]
    v_mfma_f32_16x16x32_bf16 v[112:115], v[208:211], v[232:235], v[112:115]
    s_waitcnt lgkmcnt(6)
    v_mfma_f32_16x16x32_bf16 v[116:119], v[208:211], v[236:239], v[116:119]
    v_mfma_f32_16x16x32_bf16 v[100:103], v[204:207], v[224:227], v[100:103]
    v_mfma_f32_16x16x32_bf16 v[104:107], v[204:207], v[228:231], v[104:107]
    v_mfma_f32_16x16x32_bf16 v[108:111], v[204:207], v[232:235], v[108:111]
    v_mfma_f32_16x16x32_bf16 v[112:115], v[204:207], v[236:239], v[112:115]
    s_waitcnt lgkmcnt(5)
    v_mfma_f32_16x16x32_bf16 v[116:119], v[204:207], v[240:243], v[116:119]
    v_mfma_f32_16x16x32_bf16 v[96:99], v[200:203], v[224:227], v[96:99]
    v_mfma_f32_16x16x32_bf16 v[100:103], v[200:203], v[228:231], v[100:103]
    s_barrier
    v_mfma_f32_16x16x32_bf16 v[104:107], v[200:203], v[232:235], v[104:107]
    buffer_load_dwordx4 v[56:59], v26, s[8:11], s42 offen offset:0 sc1
    v_mfma_f32_16x16x32_bf16 v[108:111], v[200:203], v[236:239], v[108:111]
    v_mfma_f32_16x16x32_bf16 v[112:115], v[200:203], v[240:243], v[112:115]
    buffer_load_dwordx4 v[60:63], v26, s[8:11], s42 offen offset:1024 sc1
    s_waitcnt lgkmcnt(4)
    v_mfma_f32_16x16x32_bf16 v[116:119], v[200:203], v[244:247], v[116:119]
    v_mfma_f32_16x16x32_bf16 v[92:95], v[196:199], v[224:227], v[92:95]
    v_mfma_f32_16x16x32_bf16 v[96:99], v[196:199], v[228:231], v[96:99]
    buffer_load_dwordx4 v[64:67], v27, s[8:11], s42 offen offset:0 sc1
    v_mfma_f32_16x16x32_bf16 v[100:103], v[196:199], v[232:235], v[100:103]
    v_mfma_f32_16x16x32_bf16 v[104:107], v[196:199], v[236:239], v[104:107]
    v_mfma_f32_16x16x32_bf16 v[108:111], v[196:199], v[240:243], v[108:111]
    buffer_load_dwordx4 v[68:71], v27, s[8:11], s42 offen offset:1024 sc1
    v_mfma_f32_16x16x32_bf16 v[112:115], v[196:199], v[244:247], v[112:115]
    s_waitcnt lgkmcnt(3)
    v_mfma_f32_16x16x32_bf16 v[116:119], v[196:199], v[248:251], v[116:119]
    s_waitcnt lgkmcnt(0)
    v_mfma_f32_16x16x32_bf16 v[88:91], v[192:195], v[224:227], v[88:91]
    buffer_load_dwordx4 v[72:75], v28, s[8:11], s42 offen offset:0 sc1
    v_mfma_f32_16x16x32_bf16 v[92:95], v[192:195], v[228:231], v[92:95]
    v_mfma_f32_16x16x32_bf16 v[96:99], v[192:195], v[232:235], v[96:99]
    v_mfma_f32_16x16x32_bf16 v[100:103], v[192:195], v[236:239], v[100:103]
    buffer_load_dwordx4 v[76:79], v28, s[8:11], s42 offen offset:1024 sc1
    v_mfma_f32_16x16x32_bf16 v[104:107], v[192:195], v[240:243], v[104:107]
    v_mfma_f32_16x16x32_bf16 v[108:111], v[192:195], v[244:247], v[108:111]
    v_mfma_f32_16x16x32_bf16 v[112:115], v[192:195], v[248:251], v[112:115]
    buffer_load_dwordx4 v[80:83], v29, s[8:11], s42 offen offset:0 sc1
    v_mfma_f32_16x16x32_bf16 v[116:119], v[192:195], v[252:255], v[116:119]
    buffer_load_dwordx4 v[84:87], v29, s[8:11], s42 offen offset:1024 sc1
    ds_read_b128 v[192:195], v22 offset:0
    ds_read_b128 v[196:199], v22 offset:2048
    ds_read_b128 v[200:203], v22 offset:4096
    ds_read_b128 v[204:207], v22 offset:6144
    ds_read_b128 v[208:211], v23 offset:0
    ds_read_b128 v[212:215], v23 offset:2048
    ds_read_b128 v[216:219], v23 offset:4096
    ds_read_b128 v[220:223], v23 offset:6144
    v_cndmask_b32 v40, v88, v104, s[52:53]
    ds_read_b128 v[224:227], v20 offset:0
    v_cndmask_b32 v41, v89, v105, s[52:53]
    v_cndmask_b32 v42, v90, v106, s[52:53]
    v_cndmask_b32 v43, v91, v107, s[52:53]
    v_cndmask_b32 v44, v92, v108, s[52:53]
    ds_read_b128 v[228:231], v20 offset:2048
    v_cndmask_b32 v45, v93, v109, s[52:53]
    v_cndmask_b32 v46, v94, v110, s[52:53]
    v_cndmask_b32 v47, v95, v111, s[52:53]
    v_cndmask_b32 v48, v96, v112, s[52:53]
    ds_read_b128 v[232:235], v20 offset:4096
    v_cndmask_b32 v49, v97, v113, s[52:53]
    v_cndmask_b32 v50, v98, v114, s[52:53]
    v_cndmask_b32 v51, v99, v115, s[52:53]
    v_cndmask_b32 v52, v100, v116, s[52:53]
    ds_read_b128 v[236:239], v20 offset:6144
    v_cndmask_b32 v53, v101, v117, s[52:53]
    v_cndmask_b32 v54, v102, v118, s[52:53]
    v_cndmask_b32 v55, v103, v119, s[52:53]
    v_cndmask_b32 v104, v104, v88, s[52:53]
    ds_read_b128 v[240:243], v21 offset:0
    v_cndmask_b32 v105, v105, v89, s[52:53]
    v_cndmask_b32 v106, v106, v90, s[52:53]
    v_cndmask_b32 v107, v107, v91, s[52:53]
    v_cndmask_b32 v108, v108, v92, s[52:53]
    ds_read_b128 v[244:247], v21 offset:2048
    v_cndmask_b32 v109, v109, v93, s[52:53]
    v_cndmask_b32 v110, v110, v94, s[52:53]
    v_cndmask_b32 v111, v111, v95, s[52:53]
    v_cndmask_b32 v112, v112, v96, s[52:53]
    ds_read_b128 v[248:251], v21 offset:4096
    v_cndmask_b32 v113, v113, v97, s[52:53]
    v_cndmask_b32 v114, v114, v98, s[52:53]
    v_cndmask_b32 v115, v115, v99, s[52:53]
    v_cndmask_b32 v116, v116, v100, s[52:53]
    ds_read_b128 v[252:255], v21 offset:6144
    v_cndmask_b32 v117, v117, v101, s[52:53]
    v_cndmask_b32 v118, v118, v102, s[52:53]
    v_cndmask_b32 v119, v119, v103, s[52:53]
    s_setprio 0
    s_and_b32 s65, s5, 7
    s_lshl_b32 s65, s65, 2
    s_lshr_b32 s65, 0x10210210, s65
    s_and_b32 s65, s65, 3
    s_lshl_b32 s65, s65, 2
    s_lshr_b32 s64, 0x10210, s65
    s_add_u32 s65, s33, 16384
    s_waitcnt vmcnt(7)
    v_mfma_f32_16x16x32_bf16 v[88:91], v[56:59], v[128:131], 0
    ds_write_b128 v13, v[104:107] offset:0
    v_mfma_f32_16x16x32_bf16 v[92:95], v[56:59], v[132:135], 0
    v_mfma_f32_16x16x32_bf16 v[96:99], v[56:59], v[136:139], 0
    ds_write_b128 v13, v[108:111] offset:1024
    v_mfma_f32_16x16x32_bf16 v[100:103], v[56:59], v[140:143], 0
    buffer_load_dwordx4 v[56:59], v26, s[8:11], s43 offen offset:0 sc1
    s_waitcnt vmcnt(7)
    v_mfma_f32_16x16x32_bf16 v[88:91], v[60:63], v[144:147], v[88:91]
    v_mfma_f32_16x16x32_bf16 v[92:95], v[60:63], v[148:151], v[92:95]
    ds_write_b128 v13, v[112:115] offset:2048
    v_mfma_f32_16x16x32_bf16 v[96:99], v[60:63], v[152:155], v[96:99]
    v_mfma_f32_16x16x32_bf16 v[100:103], v[60:63], v[156:159], v[100:103]
    buffer_load_dwordx4 v[60:63], v26, s[8:11], s43 offen offset:1024 sc1
    s_waitcnt vmcnt(7)
    v_mfma_f32_16x16x32_bf16 v[88:91], v[64:67], v[160:163], v[88:91]
    ds_write_b128 v13, v[116:119] offset:3072
    v_mfma_f32_16x16x32_bf16 v[92:95], v[64:67], v[164:167], v[92:95]
    v_mfma_f32_16x16x32_bf16 v[96:99], v[64:67], v[168:171], v[96:99]
    v_mfma_f32_16x16x32_bf16 v[100:103], v[64:67], v[172:175], v[100:103]
    buffer_load_dwordx4 v[64:67], v27, s[8:11], s43 offen offset:0 sc1
    s_waitcnt vmcnt(7)
    v_mfma_f32_16x16x32_bf16 v[88:91], v[68:71], v[176:179], v[88:91]
    v_mfma_f32_16x16x32_bf16 v[92:95], v[68:71], v[180:183], v[92:95]
    v_mfma_f32_16x16x32_bf16 v[96:99], v[68:71], v[184:187], v[96:99]
    v_mfma_f32_16x16x32_bf16 v[100:103], v[68:71], v[188:191], v[100:103]
    buffer_load_dwordx4 v[68:71], v27, s[8:11], s43 offen offset:1024 sc1
    s_waitcnt vmcnt(7) lgkmcnt(15)
    v_mfma_f32_16x16x32_bf16 v[88:91], v[72:75], v[192:195], v[88:91]
    v_mfma_f32_16x16x32_bf16 v[92:95], v[72:75], v[196:199], v[92:95]
    v_mfma_f32_16x16x32_bf16 v[96:99], v[72:75], v[200:203], v[96:99]
    v_mfma_f32_16x16x32_bf16 v[100:103], v[72:75], v[204:207], v[100:103]
    buffer_load_dwordx4 v[72:75], v28, s[8:11], s43 offen offset:0 sc1
    s_waitcnt vmcnt(7)
    v_mfma_f32_16x16x32_bf16 v[88:91], v[76:79], v[208:211], v[88:91]
    s_waitcnt lgkmcnt(14)
    v_mfma_f32_16x16x32_bf16 v[92:95], v[76:79], v[212:215], v[92:95]
    s_waitcnt lgkmcnt(13)
    v_mfma_f32_16x16x32_bf16 v[96:99], v[76:79], v[216:219], v[96:99]
    s_waitcnt lgkmcnt(12)
    v_mfma_f32_16x16x32_bf16 v[100:103], v[76:79], v[220:223], v[100:103]
    buffer_load_dwordx4 v[76:79], v28, s[8:11], s43 offen offset:1024 sc1
    s_waitcnt vmcnt(7) lgkmcnt(11)
    v_mfma_f32_16x16x32_bf16 v[88:91], v[80:83], v[224:227], v[88:91]
    s_waitcnt lgkmcnt(10)
    v_mfma_f32_16x16x32_bf16 v[92:95], v[80:83], v[228:231], v[92:95]
    s_waitcnt lgkmcnt(9)
    v_mfma_f32_16x16x32_bf16 v[96:99], v[80:83], v[232:235], v[96:99]
    s_waitcnt lgkmcnt(8)
    v_mfma_f32_16x16x32_bf16 v[100:103], v[80:83], v[236:239], v[100:103]
    buffer_load_dwordx4 v[80:83], v29, s[8:11], s43 offen offset:0 sc1
    s_waitcnt vmcnt(7) lgkmcnt(7)
    v_mfma_f32_16x16x32_bf16 v[88:91], v[84:87], v[240:243], v[88:91]
    s_waitcnt lgkmcnt(6)
    v_mfma_f32_16x16x32_bf16 v[92:95], v[84:87], v[244:247], v[92:95]
    s_waitcnt lgkmcnt(5)
    v_mfma_f32_16x16x32_bf16 v[96:99], v[84:87], v[248:251], v[96:99]
    s_waitcnt lgkmcnt(4)
    v_mfma_f32_16x16x32_bf16 v[100:103], v[84:87], v[252:255], v[100:103]
    buffer_load_dwordx4 v[84:87], v29, s[8:11], s43 offen offset:1024 sc1
    s_waitcnt vmcnt(7)
    v_mfma_f32_16x16x32_bf16 v[104:107], v[56:59], v[128:131], 0
    v_mfma_f32_16x16x32_bf16 v[108:111], v[56:59], v[132:135], 0
    v_mfma_f32_16x16x32_bf16 v[112:115], v[56:59], v[136:139], 0
    ds_write_b128 v30, v[88:91] offset:0
    v_mfma_f32_16x16x32_bf16 v[116:119], v[56:59], v[140:143], 0
    buffer_load_dwordx4 v[56:59], v26, s[8:11], s44 offen offset:0 sc1
    ds_write_b128 v31, v[92:95] offset:0
    s_waitcnt vmcnt(7)
    v_mfma_f32_16x16x32_bf16 v[104:107], v[60:63], v[144:147], v[104:107]
    ds_write_b128 v32, v[96:99] offset:0
    v_mfma_f32_16x16x32_bf16 v[108:111], v[60:63], v[148:151], v[108:111]
    ds_write_b128 v33, v[100:103] offset:0
    v_mfma_f32_16x16x32_bf16 v[112:115], v[60:63], v[152:155], v[112:115]
    v_mfma_f32_16x16x32_bf16 v[116:119], v[60:63], v[156:159], v[116:119]
    buffer_load_dwordx4 v[60:63], v26, s[8:11], s44 offen offset:1024 sc1
    s_waitcnt vmcnt(7)
    v_mfma_f32_16x16x32_bf16 v[104:107], v[64:67], v[160:163], v[104:107]
    v_mfma_f32_16x16x32_bf16 v[108:111], v[64:67], v[164:167], v[108:111]
    s_waitcnt lgkmcnt(0)
    s_barrier
    v_add_u32 v30, 53248, v30
    v_add_u32 v31, 53248, v31
    v_add_u32 v32, 53248, v32
    v_mfma_f32_16x16x32_bf16 v[112:115], v[64:67], v[168:171], v[112:115]
    v_add_u32 v33, 53248, v33
    v_mfma_f32_16x16x32_bf16 v[116:119], v[64:67], v[172:175], v[116:119]
    buffer_load_dwordx4 v[64:67], v27, s[8:11], s44 offen offset:0 sc1
    ds_read_b128 v[120:123], v14 offset:0
    s_waitcnt vmcnt(7)
    v_mfma_f32_16x16x32_bf16 v[104:107], v[68:71], v[176:179], v[104:107]
    ds_read_b128 v[124:127], v14 offset:1024
    v_mfma_f32_16x16x32_bf16 v[108:111], v[68:71], v[180:183], v[108:111]
    v_mfma_f32_16x16x32_bf16 v[112:115], v[68:71], v[184:187], v[112:115]
    v_mfma_f32_16x16x32_bf16 v[116:119], v[68:71], v[188:191], v[116:119]
    buffer_load_dwordx4 v[68:71], v27, s[8:11], s44 offen offset:1024 sc1
    s_waitcnt vmcnt(7)
    v_mfma_f32_16x16x32_bf16 v[104:107], v[72:75], v[192:195], v[104:107]
    v_mfma_f32_16x16x32_bf16 v[108:111], v[72:75], v[196:199], v[108:111]
    s_waitcnt lgkmcnt(1)
    v_add_f32 v40, v40, v120
    v_add_f32 v41, v41, v121
    v_add_f32 v42, v42, v122
    v_mfma_f32_16x16x32_bf16 v[112:115], v[72:75], v[200:203], v[112:115]
    v_add_f32 v43, v43, v123
    s_waitcnt lgkmcnt(0)
    v_add_f32 v44, v44, v124
    v_add_f32 v45, v45, v125
    v_mfma_f32_16x16x32_bf16 v[116:119], v[72:75], v[204:207], v[116:119]
    buffer_load_dwordx4 v[72:75], v28, s[8:11], s44 offen offset:0 sc1
    v_add_f32 v46, v46, v126
    v_add_f32 v47, v47, v127
    s_waitcnt vmcnt(7)
    v_mfma_f32_16x16x32_bf16 v[104:107], v[76:79], v[208:211], v[104:107]
    v_mfma_f32_16x16x32_bf16 v[108:111], v[76:79], v[212:215], v[108:111]
    ds_read_b128 v[120:123], v14 offset:2048
    ds_read_b128 v[124:127], v14 offset:3072
    v_mfma_f32_16x16x32_bf16 v[112:115], v[76:79], v[216:219], v[112:115]
    v_mfma_f32_16x16x32_bf16 v[116:119], v[76:79], v[220:223], v[116:119]
    buffer_load_dwordx4 v[76:79], v28, s[8:11], s44 offen offset:1024 sc1
    s_waitcnt vmcnt(7)
    v_mfma_f32_16x16x32_bf16 v[104:107], v[80:83], v[224:227], v[104:107]
    v_mfma_f32_16x16x32_bf16 v[108:111], v[80:83], v[228:231], v[108:111]
    v_mfma_f32_16x16x32_bf16 v[112:115], v[80:83], v[232:235], v[112:115]
    v_mfma_f32_16x16x32_bf16 v[116:119], v[80:83], v[236:239], v[116:119]
    buffer_load_dwordx4 v[80:83], v29, s[8:11], s44 offen offset:0 sc1
    s_waitcnt lgkmcnt(1)
    v_add_f32 v48, v48, v120
    v_add_f32 v49, v49, v121
    s_waitcnt vmcnt(7)
    v_mfma_f32_16x16x32_bf16 v[104:107], v[84:87], v[240:243], v[104:107]
    v_add_f32 v50, v50, v122
    v_add_f32 v51, v51, v123
    s_waitcnt lgkmcnt(0)
    v_add_f32 v52, v52, v124
    v_add_f32 v53, v53, v125
    v_mfma_f32_16x16x32_bf16 v[108:111], v[84:87], v[244:247], v[108:111]
    v_add_f32 v54, v54, v126
    v_add_f32 v55, v55, v127
    v_mfma_f32_16x16x32_bf16 v[112:115], v[84:87], v[248:251], v[112:115]
    v_mfma_f32_16x16x32_bf16 v[116:119], v[84:87], v[252:255], v[116:119]
    buffer_load_dwordx4 v[84:87], v29, s[8:11], s44 offen offset:1024 sc1
    s_waitcnt vmcnt(7)
    v_mfma_f32_16x16x32_bf16 v[88:91], v[56:59], v[128:131], 0
    v_mfma_f32_16x16x32_bf16 v[92:95], v[56:59], v[132:135], 0
    v_mfma_f32_16x16x32_bf16 v[96:99], v[56:59], v[136:139], 0
    ds_write_b128 v30, v[104:107] offset:0
    v_mfma_f32_16x16x32_bf16 v[100:103], v[56:59], v[140:143], 0
    buffer_load_dwordx4 v[56:59], v26, s[8:11], s45 offen offset:0 sc1
    ds_write_b128 v31, v[108:111] offset:0
    s_waitcnt vmcnt(7)
    v_mfma_f32_16x16x32_bf16 v[88:91], v[60:63], v[144:147], v[88:91]
    ds_write_b128 v32, v[112:115] offset:0
    v_mfma_f32_16x16x32_bf16 v[92:95], v[60:63], v[148:151], v[92:95]
    ds_write_b128 v33, v[116:119] offset:0
    v_mfma_f32_16x16x32_bf16 v[96:99], v[60:63], v[152:155], v[96:99]
    v_mfma_f32_16x16x32_bf16 v[100:103], v[60:63], v[156:159], v[100:103]
    buffer_load_dwordx4 v[60:63], v26, s[8:11], s45 offen offset:1024 sc1
    s_waitcnt vmcnt(7)
    v_mfma_f32_16x16x32_bf16 v[88:91], v[64:67], v[160:163], v[88:91]
    v_mfma_f32_16x16x32_bf16 v[92:95], v[64:67], v[164:167], v[92:95]
    s_waitcnt lgkmcnt(0)
    s_barrier
    v_mfma_f32_16x16x32_bf16 v[96:99], v[64:67], v[168:171], v[96:99]
    v_mfma_f32_16x16x32_bf16 v[100:103], v[64:67], v[172:175], v[100:103]
    buffer_load_dwordx4 v[64:67], v27, s[8:11], s45 offen offset:0 sc1
    v_cvt_pk_bf16_f32 v40, v40, v41
    v_cvt_pk_bf16_f32 v41, v42, v43
    s_waitcnt vmcnt(7)
    v_mfma_f32_16x16x32_bf16 v[88:91], v[68:71], v[176:179], v[88:91]
    ds_write_b64 v15, v[40:41] offset:0
    v_mfma_f32_16x16x32_bf16 v[92:95], v[68:71], v[180:183], v[92:95]
    v_cvt_pk_bf16_f32 v44, v44, v45
    v_cvt_pk_bf16_f32 v45, v46, v47
    v_mfma_f32_16x16x32_bf16 v[96:99], v[68:71], v[184:187], v[96:99]
    ds_write_b64 v15, v[44:45] offset:512
    v_mfma_f32_16x16x32_bf16 v[100:103], v[68:71], v[188:191], v[100:103]
    buffer_load_dwordx4 v[68:71], v27, s[8:11], s45 offen offset:1024 sc1
    v_cvt_pk_bf16_f32 v48, v48, v49
    v_cvt_pk_bf16_f32 v49, v50, v51
    s_waitcnt vmcnt(7)
    v_mfma_f32_16x16x32_bf16 v[88:91], v[72:75], v[192:195], v[88:91]
    ds_write_b64 v15, v[48:49] offset:1024
    v_mfma_f32_16x16x32_bf16 v[92:95], v[72:75], v[196:199], v[92:95]
    v_cvt_pk_bf16_f32 v52, v52, v53
    v_cvt_pk_bf16_f32 v53, v54, v55
    v_mfma_f32_16x16x32_bf16 v[96:99], v[72:75], v[200:203], v[96:99]
    ds_write_b64 v15, v[52:53] offset:1536
    v_mfma_f32_16x16x32_bf16 v[100:103], v[72:75], v[204:207], v[100:103]
    buffer_load_dwordx4 v[72:75], v28, s[8:11], s45 offen offset:0 sc1
    s_waitcnt vmcnt(7)
    v_mfma_f32_16x16x32_bf16 v[88:91], v[76:79], v[208:211], v[88:91]
    ds_read_b128 v[120:123], v14 offset:0
    ds_read_b128 v[124:127], v14 offset:1024
    v_mfma_f32_16x16x32_bf16 v[92:95], v[76:79], v[212:215], v[92:95]
    s_lshr_b32 s32, s57, 1
    s_lshl_b32 s32, s32, 7
    s_add_u32 s32, s32, 17203200
    v_mfma_f32_16x16x32_bf16 v[96:99], v[76:79], v[216:219], v[96:99]
    v_mfma_f32_16x16x32_bf16 v[100:103], v[76:79], v[220:223], v[100:103]
    buffer_load_dwordx4 v[76:79], v28, s[8:11], s45 offen offset:1024 sc1
    s_waitcnt vmcnt(7)
    v_mfma_f32_16x16x32_bf16 v[88:91], v[80:83], v[224:227], v[88:91]
    v_mfma_f32_16x16x32_bf16 v[92:95], v[80:83], v[228:231], v[92:95]
    v_mfma_f32_16x16x32_bf16 v[96:99], v[80:83], v[232:235], v[96:99]
    v_mfma_f32_16x16x32_bf16 v[100:103], v[80:83], v[236:239], v[100:103]
    buffer_load_dwordx4 v[80:83], v29, s[8:11], s45 offen offset:0 sc1
    s_waitcnt lgkmcnt(1)
    buffer_store_dwordx4 v[120:123], v1, s[8:11], s35 offen offset:0 sc1
    s_waitcnt vmcnt(8)
    v_mfma_f32_16x16x32_bf16 v[88:91], v[84:87], v[240:243], v[88:91]
    v_mfma_f32_16x16x32_bf16 v[92:95], v[84:87], v[244:247], v[92:95]
    s_waitcnt lgkmcnt(0)
    buffer_store_dwordx4 v[124:127], v1, s[8:11], s35 offen offset:1024 sc1
    v_mfma_f32_16x16x32_bf16 v[96:99], v[84:87], v[248:251], v[96:99]
    v_mfma_f32_16x16x32_bf16 v[100:103], v[84:87], v[252:255], v[100:103]
    buffer_load_dwordx4 v[84:87], v29, s[8:11], s45 offen offset:1024 sc1
    s_waitcnt vmcnt(9)
    v_mfma_f32_16x16x32_bf16 v[104:107], v[56:59], v[128:131], 0
    v_mfma_f32_16x16x32_bf16 v[108:111], v[56:59], v[132:135], 0
    v_mfma_f32_16x16x32_bf16 v[112:115], v[56:59], v[136:139], 0
    ds_write_b128 v30, v[88:91] offset:28672
    v_mfma_f32_16x16x32_bf16 v[116:119], v[56:59], v[140:143], 0
    buffer_load_dwordx4 v[56:59], v26, s[8:11], s46 offen offset:0 sc1
    ds_write_b128 v31, v[92:95] offset:28672
    s_waitcnt vmcnt(9)
    v_mfma_f32_16x16x32_bf16 v[104:107], v[60:63], v[144:147], v[104:107]
    ds_write_b128 v32, v[96:99] offset:28672
    v_mfma_f32_16x16x32_bf16 v[108:111], v[60:63], v[148:151], v[108:111]
    ds_write_b128 v33, v[100:103] offset:28672
    v_mfma_f32_16x16x32_bf16 v[112:115], v[60:63], v[152:155], v[112:115]
    v_mfma_f32_16x16x32_bf16 v[116:119], v[60:63], v[156:159], v[116:119]
    buffer_load_dwordx4 v[60:63], v26, s[8:11], s46 offen offset:1024 sc1
    s_waitcnt vmcnt(9)
    v_mfma_f32_16x16x32_bf16 v[104:107], v[64:67], v[160:163], v[104:107]
    v_mfma_f32_16x16x32_bf16 v[108:111], v[64:67], v[164:167], v[108:111]
    s_waitcnt lgkmcnt(0)
    s_barrier
    v_mfma_f32_16x16x32_bf16 v[112:115], v[64:67], v[168:171], v[112:115]
    v_mfma_f32_16x16x32_bf16 v[116:119], v[64:67], v[172:175], v[116:119]
    buffer_load_dwordx4 v[64:67], v27, s[8:11], s46 offen offset:0 sc1
    v_bfe_u32 v121, v0, 2, 4
    v_bfe_u32 v122, v0, 3, 2
    s_waitcnt vmcnt(9)
    v_mfma_f32_16x16x32_bf16 v[104:107], v[68:71], v[176:179], v[104:107]
    v_and_b32 v123, 3, v0
    v_mfma_f32_16x16x32_bf16 v[108:111], v[68:71], v[180:183], v[108:111]
    v_lshlrev_b32_e64 v121, 7, v121
    v_mfma_f32_16x16x32_bf16 v[112:115], v[68:71], v[184:187], v[112:115]
    v_lshl_add_u32 v121, v123, 3, v121
    v_mfma_f32_16x16x32_bf16 v[116:119], v[68:71], v[188:191], v[116:119]
    buffer_load_dwordx4 v[68:71], v27, s[8:11], s46 offen offset:1024 sc1
    v_lshl_add_u32 v40, v122, 5, v121
    s_waitcnt vmcnt(9)
    v_mfma_f32_16x16x32_bf16 v[104:107], v[72:75], v[192:195], v[104:107]
    s_lshl_b32 s7, s3, 5
    v_xor_b32_e64 v48, s7, v40
    v_mfma_f32_16x16x32_bf16 v[108:111], v[72:75], v[196:199], v[108:111]
    v_add_u32 v40, 73728, v40
    v_mfma_f32_16x16x32_bf16 v[112:115], v[72:75], v[200:203], v[112:115]
    v_xor_b32 v41, 32, v40
    v_mfma_f32_16x16x32_bf16 v[116:119], v[72:75], v[204:207], v[116:119]
    buffer_load_dwordx4 v[72:75], v28, s[8:11], s46 offen offset:0 sc1
    v_xor_b32_e64 v42, 64, v40
    s_waitcnt vmcnt(9)
    v_mfma_f32_16x16x32_bf16 v[104:107], v[76:79], v[208:211], v[104:107]
    v_xor_b32 v43, 96, v40
    v_mfma_f32_16x16x32_bf16 v[108:111], v[76:79], v[212:215], v[108:111]
    s_lshl_b32 s7, s51, 10
    s_add_u32 s7, s7, 17367552
    v_mfma_f32_16x16x32_bf16 v[112:115], v[76:79], v[216:219], v[112:115]
    v_lshl_add_u32 v49, v123, 7, s7
    v_mfma_f32_16x16x32_bf16 v[116:119], v[76:79], v[220:223], v[116:119]
    buffer_load_dwordx4 v[76:79], v28, s[8:11], s46 offen offset:1024 sc1
    s_add_u32 s7, s33, 131072
    s_waitcnt vmcnt(9)
    v_mfma_f32_16x16x32_bf16 v[104:107], v[80:83], v[224:227], v[104:107]
    v_add_u32 v50, s7, v1
    v_mfma_f32_16x16x32_bf16 v[108:111], v[80:83], v[228:231], v[108:111]
    v_and_b32 v121, 15, v0
    v_mfma_f32_16x16x32_bf16 v[112:115], v[80:83], v[232:235], v[112:115]
    v_bfe_u32 v122, v0, 1, 3
    v_lshrrev_b32 v123, 5, v0
    v_mfma_f32_16x16x32_bf16 v[116:119], v[80:83], v[236:239], v[116:119]
    buffer_load_dwordx4 v[80:83], v29, s[8:11], s46 offen offset:0 sc1
    v_xor_b32 v122, v122, v123
    s_waitcnt vmcnt(7)
    v_mfma_f32_16x16x32_bf16 v[104:107], v[84:87], v[240:243], v[104:107]
    v_bfe_u32 v123, v0, 4, 1
    v_mfma_f32_16x16x32_bf16 v[108:111], v[84:87], v[244:247], v[108:111]
    v_lshlrev_b32 v123, 3, v123
    v_mfma_f32_16x16x32_bf16 v[112:115], v[84:87], v[248:251], v[112:115]
    v_lshl_add_u32 v123, v121, 7, v123
    v_mfma_f32_16x16x32_bf16 v[116:119], v[84:87], v[252:255], v[116:119]
    buffer_load_dwordx4 v[84:87], v29, s[8:11], s46 offen offset:1024 sc1
    v_add_u32 v123, s55, v123
    s_waitcnt vmcnt(7)
    v_mfma_f32_16x16x32_bf16 v[88:91], v[56:59], v[128:131], 0
    v_mfma_f32_16x16x32_bf16 v[92:95], v[56:59], v[132:135], 0
    v_mfma_f32_16x16x32_bf16 v[96:99], v[56:59], v[136:139], 0
    ds_write_b128 v30, v[104:107] offset:0
    v_mfma_f32_16x16x32_bf16 v[100:103], v[56:59], v[140:143], 0
    buffer_load_dwordx4 v[56:59], v26, s[8:11], s47 offen offset:0 sc1
    ds_write_b128 v31, v[108:111] offset:0
    s_waitcnt vmcnt(7)
    v_mfma_f32_16x16x32_bf16 v[88:91], v[60:63], v[144:147], v[88:91]
    ds_write_b128 v32, v[112:115] offset:0
    v_mfma_f32_16x16x32_bf16 v[92:95], v[60:63], v[148:151], v[92:95]
    ds_write_b128 v33, v[116:119] offset:0
    v_mfma_f32_16x16x32_bf16 v[96:99], v[60:63], v[152:155], v[96:99]
    v_mfma_f32_16x16x32_bf16 v[100:103], v[60:63], v[156:159], v[100:103]
    buffer_load_dwordx4 v[60:63], v26, s[8:11], s47 offen offset:1024 sc1
    s_waitcnt vmcnt(7)
    v_mfma_f32_16x16x32_bf16 v[88:91], v[64:67], v[160:163], v[88:91]
    v_mfma_f32_16x16x32_bf16 v[92:95], v[64:67], v[164:167], v[92:95]
    s_waitcnt lgkmcnt(0)
    s_barrier
    v_mfma_f32_16x16x32_bf16 v[96:99], v[64:67], v[168:171], v[96:99]
    buffer_store_dwordx2 v[2:3], v34, s[8:11], s32 offen sc1
    v_mfma_f32_16x16x32_bf16 v[100:103], v[64:67], v[172:175], v[100:103]
    buffer_load_dwordx4 v[64:67], v27, s[8:11], s47 offen offset:0 sc1
    s_waitcnt vmcnt(8)
    v_mfma_f32_16x16x32_bf16 v[88:91], v[68:71], v[176:179], v[88:91]
    v_lshl_add_u32 v44, v122, 4, v123
    v_xor_b32 v45, 32, v44
    v_mfma_f32_16x16x32_bf16 v[92:95], v[68:71], v[180:183], v[92:95]
    v_xor_b32 v46, 64, v44
    v_mfma_f32_16x16x32_bf16 v[96:99], v[68:71], v[184:187], v[96:99]
    v_xor_b32 v47, 96, v44
    v_mfma_f32_16x16x32_bf16 v[100:103], v[68:71], v[188:191], v[100:103]
    buffer_load_dwordx4 v[68:71], v27, s[8:11], s47 offen offset:1024 sc1
    v_add_u32 v51, s55, v1
    s_waitcnt vmcnt(8)
    v_mfma_f32_16x16x32_bf16 v[88:91], v[72:75], v[192:195], v[88:91]
    v_lshrrev_b32 v121, 3, v0
    v_mfma_f32_16x16x32_bf16 v[92:95], v[72:75], v[196:199], v[92:95]
    v_and_b32 v122, 7, v0
    v_mfma_f32_16x16x32_bf16 v[96:99], v[72:75], v[200:203], v[96:99]
    v_lshrrev_b32 v123, 4, v0
    v_xor_b32 v122, v122, v123
    v_mfma_f32_16x16x32_bf16 v[100:103], v[72:75], v[204:207], v[100:103]
    buffer_load_dwordx4 v[72:75], v28, s[8:11], s47 offen offset:0 sc1
    v_lshlrev_b32 v122, 4, v122
    s_waitcnt vmcnt(8)
    v_mfma_f32_16x16x32_bf16 v[88:91], v[76:79], v[208:211], v[88:91]
    v_lshl_add_u32 v52, v121, 10, v122
    v_mfma_f32_16x16x32_bf16 v[92:95], v[76:79], v[212:215], v[92:95]
    v_xor_b32 v53, 64, v52
    v_mfma_f32_16x16x32_bf16 v[96:99], v[76:79], v[216:219], v[96:99]
    v_add_u32 v53, 7168, v53
    v_mfma_f32_16x16x32_bf16 v[100:103], v[76:79], v[220:223], v[100:103]
    buffer_load_dwordx4 v[76:79], v28, s[8:11], s47 offen offset:1024 sc1
    v_lshrrev_b32 v54, 3, v0
    s_waitcnt vmcnt(8)
    v_mfma_f32_16x16x32_bf16 v[88:91], v[80:83], v[224:227], v[88:91]
    v_mul_u32_u24 v54, 3072, v54
    v_add_u32 v54, v4, v54
    v_mfma_f32_16x16x32_bf16 v[92:95], v[80:83], v[228:231], v[92:95]
    v_add_u32 v55, 31744, v54
    v_mfma_f32_16x16x32_bf16 v[96:99], v[80:83], v[232:235], v[96:99]
    s_lshl2_add_u32 s32, s4, s3
    v_mfma_f32_16x16x32_bf16 v[100:103], v[80:83], v[236:239], v[100:103]
    buffer_load_dwordx4 v[80:83], v29, s[8:11], s47 offen offset:0 sc1
    s_lshl_b32 s57, s32, 16
    s_waitcnt vmcnt(8)
    v_mfma_f32_16x16x32_bf16 v[88:91], v[84:87], v[240:243], v[88:91]
    s_lshl_b32 s32, s5, 7
    v_mfma_f32_16x16x32_bf16 v[92:95], v[84:87], v[244:247], v[92:95]
    s_add_u32 s57, s57, s32
    v_mfma_f32_16x16x32_bf16 v[96:99], v[84:87], v[248:251], v[96:99]
    s_add_u32 s57, s57, 14680064
    v_mfma_f32_16x16x32_bf16 v[100:103], v[84:87], v[252:255], v[100:103]
    buffer_load_dwordx4 v[84:87], v29, s[8:11], s47 offen offset:1024 sc1
    s_waitcnt vmcnt(8)
    v_mfma_f32_16x16x32_bf16 v[104:107], v[56:59], v[128:131], 0
    v_mfma_f32_16x16x32_bf16 v[108:111], v[56:59], v[132:135], 0
    v_mfma_f32_16x16x32_bf16 v[112:115], v[56:59], v[136:139], 0
    ds_write_b128 v30, v[88:91] offset:28672
    v_mfma_f32_16x16x32_bf16 v[116:119], v[56:59], v[140:143], 0
    buffer_load_dwordx4 v[56:59], v26, s[8:11], s48 offen offset:0 sc1
    ds_write_b128 v31, v[92:95] offset:28672
    s_waitcnt vmcnt(8)
    v_mfma_f32_16x16x32_bf16 v[104:107], v[60:63], v[144:147], v[104:107]
    ds_write_b128 v32, v[96:99] offset:28672
    v_mfma_f32_16x16x32_bf16 v[108:111], v[60:63], v[148:151], v[108:111]
    ds_write_b128 v33, v[100:103] offset:28672
    v_mfma_f32_16x16x32_bf16 v[112:115], v[60:63], v[152:155], v[112:115]
    v_mfma_f32_16x16x32_bf16 v[116:119], v[60:63], v[156:159], v[116:119]
    buffer_load_dwordx4 v[60:63], v26, s[8:11], s48 offen offset:1024 sc1
    s_waitcnt vmcnt(7)
    v_mfma_f32_16x16x32_bf16 v[104:107], v[64:67], v[160:163], v[104:107]
    v_mfma_f32_16x16x32_bf16 v[108:111], v[64:67], v[164:167], v[108:111]
    s_waitcnt lgkmcnt(0)
    s_barrier
    v_mfma_f32_16x16x32_bf16 v[112:115], v[64:67], v[168:171], v[112:115]
    v_mfma_f32_16x16x32_bf16 v[116:119], v[64:67], v[172:175], v[116:119]
    buffer_load_dwordx4 v[64:67], v27, s[8:11], s48 offen offset:0 sc1
    buffer_load_dwordx2 v[36:37], v35, s[8:11], s41 offen sc1
    s_waitcnt vmcnt(8)
    v_mfma_f32_16x16x32_bf16 v[104:107], v[68:71], v[176:179], v[104:107]
    v_mfma_f32_16x16x32_bf16 v[108:111], v[68:71], v[180:183], v[108:111]
    v_mfma_f32_16x16x32_bf16 v[112:115], v[68:71], v[184:187], v[112:115]
    v_mfma_f32_16x16x32_bf16 v[116:119], v[68:71], v[188:191], v[116:119]
    buffer_load_dwordx4 v[68:71], v27, s[8:11], s48 offen offset:1024 sc1
    s_waitcnt vmcnt(8)
    v_mfma_f32_16x16x32_bf16 v[104:107], v[72:75], v[192:195], v[104:107]
    v_mfma_f32_16x16x32_bf16 v[108:111], v[72:75], v[196:199], v[108:111]
    v_mfma_f32_16x16x32_bf16 v[112:115], v[72:75], v[200:203], v[112:115]
    v_mfma_f32_16x16x32_bf16 v[116:119], v[72:75], v[204:207], v[116:119]
    buffer_load_dwordx4 v[72:75], v28, s[8:11], s48 offen offset:0 sc1
    s_waitcnt vmcnt(8)
    v_mfma_f32_16x16x32_bf16 v[104:107], v[76:79], v[208:211], v[104:107]
    v_mfma_f32_16x16x32_bf16 v[108:111], v[76:79], v[212:215], v[108:111]
    v_mfma_f32_16x16x32_bf16 v[112:115], v[76:79], v[216:219], v[112:115]
    v_mfma_f32_16x16x32_bf16 v[116:119], v[76:79], v[220:223], v[116:119]
    buffer_load_dwordx4 v[76:79], v28, s[8:11], s48 offen offset:1024 sc1
    s_waitcnt vmcnt(8)
    v_mfma_f32_16x16x32_bf16 v[104:107], v[80:83], v[224:227], v[104:107]
    v_mfma_f32_16x16x32_bf16 v[108:111], v[80:83], v[228:231], v[108:111]
    v_mfma_f32_16x16x32_bf16 v[112:115], v[80:83], v[232:235], v[112:115]
    v_mfma_f32_16x16x32_bf16 v[116:119], v[80:83], v[236:239], v[116:119]
    buffer_load_dwordx4 v[80:83], v29, s[8:11], s48 offen offset:0 sc1
    s_waitcnt vmcnt(8)
    v_mfma_f32_16x16x32_bf16 v[104:107], v[84:87], v[240:243], v[104:107]
    v_mfma_f32_16x16x32_bf16 v[108:111], v[84:87], v[244:247], v[108:111]
    s_mov_b32 s40, 0
recurrent_scan__ssm_conv_s4d__mixer_gmlp__prompt_kernel_s5_chk:
    s_waitcnt vmcnt(4)
    v_cmp_ne_u64 vcc, v[36:37], v[2:3]
    s_nop 1
    s_cbranch_vccnz recurrent_scan__ssm_conv_s4d__mixer_gmlp__prompt_kernel_s5_retry
recurrent_scan__ssm_conv_s4d__mixer_gmlp__prompt_kernel_s5_ok:
    v_mfma_f32_16x16x32_bf16 v[112:115], v[84:87], v[248:251], v[112:115]
    s_sub_u32 m0, s55, 4096
    s_nop 0
    buffer_load_dwordx4 v54, s[8:11], s57 offen offset:0 sc1 lds
    v_mfma_f32_16x16x32_bf16 v[116:119], v[84:87], v[252:255], v[116:119]
    buffer_load_dwordx4 v55, s[8:11], s57 offen offset:1024 sc1 lds
    s_lshl_b32 s41, s51, 10
    s_add_u32 s41, s41, 17236480
    v_mfma_f32_16x16x32_bf16 v[88:91], v[56:59], v[128:131], 0
    buffer_load_dwordx4 v[84:87], v29, s[8:11], s48 offen offset:1024 sc1
    v_and_b32 v35, 0x180, v35
    v_mfma_f32_16x16x32_bf16 v[92:95], v[56:59], v[132:135], 0
    v_mfma_f32_16x16x32_bf16 v[96:99], v[56:59], v[136:139], 0
    ds_write_b128 v30, v[104:107] offset:0
    v_mfma_f32_16x16x32_bf16 v[100:103], v[56:59], v[140:143], 0
    ds_write_b128 v31, v[108:111] offset:0
    v_mfma_f32_16x16x32_bf16 v[88:91], v[60:63], v[144:147], v[88:91]
    ds_write_b128 v32, v[112:115] offset:0
    v_mfma_f32_16x16x32_bf16 v[92:95], v[60:63], v[148:151], v[92:95]
    ds_write_b128 v33, v[116:119] offset:0
    s_lshr_b32 s40, s64, 0
    s_and_b32 s40, s40, 7
    v_mfma_f32_16x16x32_bf16 v[96:99], v[60:63], v[152:155], v[96:99]
    s_lshl_b32 s40, s40, 14
    v_mfma_f32_16x16x32_bf16 v[100:103], v[60:63], v[156:159], v[100:103]
    s_add_u32 m0, s65, s40
    v_mfma_f32_16x16x32_bf16 v[88:91], v[64:67], v[160:163], v[88:91]
    s_lshl3_add_u32 s40, s40, s56
    v_mfma_f32_16x16x32_bf16 v[92:95], v[64:67], v[164:167], v[92:95]
    s_waitcnt lgkmcnt(0)
    s_barrier
    buffer_load_dwordx4 v4, s[24:27], s40 offen offset:0 lds
    v_mfma_f32_16x16x32_bf16 v[96:99], v[64:67], v[168:171], v[96:99]
    buffer_load_dwordx4 v5, s[24:27], s40 offen offset:1024 lds
    v_mfma_f32_16x16x32_bf16 v[100:103], v[64:67], v[172:175], v[100:103]
    buffer_load_dwordx4 v6, s[24:27], s40 offen offset:2048 lds
    s_waitcnt vmcnt(9)
    v_mfma_f32_16x16x32_bf16 v[88:91], v[68:71], v[176:179], v[88:91]
    buffer_load_dwordx4 v7, s[24:27], s40 offen offset:3072 lds
    v_mfma_f32_16x16x32_bf16 v[92:95], v[68:71], v[180:183], v[92:95]
    s_lshr_b32 s40, s64, 4
    v_mfma_f32_16x16x32_bf16 v[96:99], v[68:71], v[184:187], v[96:99]
    s_and_b32 s40, s40, 7
    v_mfma_f32_16x16x32_bf16 v[100:103], v[68:71], v[188:191], v[100:103]
    s_lshl_b32 s40, s40, 14
    s_waitcnt vmcnt(9)
    v_mfma_f32_16x16x32_bf16 v[88:91], v[72:75], v[192:195], v[88:91]
    s_add_u32 m0, s65, s40
    v_mfma_f32_16x16x32_bf16 v[92:95], v[72:75], v[196:199], v[92:95]
    s_lshl3_add_u32 s40, s40, s56
    v_mfma_f32_16x16x32_bf16 v[96:99], v[72:75], v[200:203], v[96:99]
    buffer_load_dwordx4 v4, s[24:27], s40 offen offset:0 lds
    v_mfma_f32_16x16x32_bf16 v[100:103], v[72:75], v[204:207], v[100:103]
    buffer_load_dwordx4 v5, s[24:27], s40 offen offset:1024 lds
    s_waitcnt vmcnt(10)
    v_mfma_f32_16x16x32_bf16 v[88:91], v[76:79], v[208:211], v[88:91]
    buffer_load_dwordx4 v6, s[24:27], s40 offen offset:2048 lds
    v_mfma_f32_16x16x32_bf16 v[92:95], v[76:79], v[212:215], v[92:95]
    buffer_load_dwordx4 v7, s[24:27], s40 offen offset:3072 lds
    v_mfma_f32_16x16x32_bf16 v[96:99], v[76:79], v[216:219], v[96:99]
    s_lshr_b32 s40, s64, 8
    v_mfma_f32_16x16x32_bf16 v[100:103], v[76:79], v[220:223], v[100:103]
    s_and_b32 s40, s40, 7
    s_waitcnt vmcnt(11)
    v_mfma_f32_16x16x32_bf16 v[88:91], v[80:83], v[224:227], v[88:91]
    s_lshl_b32 s40, s40, 14
    v_mfma_f32_16x16x32_bf16 v[92:95], v[80:83], v[228:231], v[92:95]
    s_add_u32 m0, s65, s40
    v_mfma_f32_16x16x32_bf16 v[96:99], v[80:83], v[232:235], v[96:99]
    s_lshl3_add_u32 s40, s40, s56
    v_mfma_f32_16x16x32_bf16 v[100:103], v[80:83], v[236:239], v[100:103]
    buffer_load_dwordx4 v4, s[24:27], s40 offen offset:0 lds
    s_waitcnt vmcnt(9)
    v_mfma_f32_16x16x32_bf16 v[88:91], v[84:87], v[240:243], v[88:91]
    buffer_load_dwordx4 v5, s[24:27], s40 offen offset:1024 lds
    v_mfma_f32_16x16x32_bf16 v[92:95], v[84:87], v[244:247], v[92:95]
    buffer_load_dwordx4 v6, s[24:27], s40 offen offset:2048 lds
    v_mfma_f32_16x16x32_bf16 v[96:99], v[84:87], v[248:251], v[96:99]
    buffer_load_dwordx4 v7, s[24:27], s40 offen offset:3072 lds
    v_mfma_f32_16x16x32_bf16 v[100:103], v[84:87], v[252:255], v[100:103]
    buffer_load_dwordx2 v[36:37], v35, s[8:11], s41 offen sc1
    s_nop 0
    ds_write_b128 v30, v[88:91] offset:28672
    s_nop 0
    ds_write_b128 v31, v[92:95] offset:28672
    s_nop 0
    ds_write_b128 v32, v[96:99] offset:28672
    s_nop 0
    ds_write_b128 v33, v[100:103] offset:28672
    s_add_u32 m0, s33, 65536
    s_add_u32 s40, s56, 393216
    buffer_load_dwordx4 v4, s[24:27], s40 offen offset:0 lds
    buffer_load_dwordx4 v5, s[24:27], s40 offen offset:1024 lds
    buffer_load_dwordx4 v6, s[24:27], s40 offen offset:2048 lds
    buffer_load_dwordx4 v7, s[24:27], s40 offen offset:3072 lds
    s_add_u32 m0, s33, 81920
    s_add_u32 s40, s56, 524288
    buffer_load_dwordx4 v4, s[24:27], s40 offen offset:0 lds
    buffer_load_dwordx4 v5, s[24:27], s40 offen offset:1024 lds
    buffer_load_dwordx4 v6, s[24:27], s40 offen offset:2048 lds
    buffer_load_dwordx4 v7, s[24:27], s40 offen offset:3072 lds
    s_waitcnt vmcnt(9) lgkmcnt(0)
    s_barrier
    s_add_u32 m0, s33, 98304
    s_add_u32 s40, s56, 655360
    buffer_load_dwordx4 v4, s[24:27], s40 offen offset:0 lds
    buffer_load_dwordx4 v5, s[24:27], s40 offen offset:1024 lds
    buffer_load_dwordx4 v6, s[24:27], s40 offen offset:2048 lds
    buffer_load_dwordx4 v7, s[24:27], s40 offen offset:3072 lds
    s_add_u32 m0, s33, 114688
    s_add_u32 s40, s56, 786432
    buffer_load_dwordx4 v4, s[24:27], s40 offen offset:0 lds
    buffer_load_dwordx4 v5, s[24:27], s40 offen offset:1024 lds
    buffer_load_dwordx4 v6, s[24:27], s40 offen offset:2048 lds
    buffer_load_dwordx4 v7, s[24:27], s40 offen offset:3072 lds
    s_mov_b32 s40, 0
recurrent_scan__ssm_conv_s4d__mixer_gmlp__prompt_kernel_s4aH_chk:
    s_waitcnt vmcnt(16)
    v_cmp_ne_u64 vcc, v[36:37], v[2:3]
    s_nop 1
    s_cbranch_vccnz recurrent_scan__ssm_conv_s4d__mixer_gmlp__prompt_kernel_s4aH_retry
recurrent_scan__ssm_conv_s4d__mixer_gmlp__prompt_kernel_s4aH_ok:
    s_add_u32 s7, s50, 16384
    buffer_load_dwordx4 v[56:59], v1, s[8:11], s7 offen offset:0 sc1
    buffer_load_dwordx4 v[60:63], v1, s[8:11], s7 offen offset:1024 sc1
    s_add_u32 s7, s50, 20480
    buffer_load_dwordx4 v[64:67], v1, s[8:11], s7 offen offset:0 sc1
    buffer_load_dwordx4 v[68:71], v1, s[8:11], s7 offen offset:1024 sc1
    ds_read_b64 v[104:105], v44
    ds_read_b64_tr_b16 v[4:5], v48 offset:0
    ds_read_b64 v[106:107], v45
    ds_read_b64_tr_b16 v[6:7], v48 offset:2048
    ds_read_b64 v[108:109], v46
    ds_read_b64_tr_b16 v[8:9], v48 offset:8192
    ds_read_b64 v[110:111], v47
    ds_read_b64_tr_b16 v[10:11], v48 offset:10240
    s_waitcnt lgkmcnt(7)
    v_lshlrev_b32 v128, 16, v104
    v_and_b32 v129, s61, v104
    v_lshlrev_b32 v130, 16, v105
    v_and_b32 v131, s61, v105
    s_waitcnt lgkmcnt(5)
    v_lshlrev_b32 v132, 16, v106
    v_and_b32 v133, s61, v106
    v_lshlrev_b32 v134, 16, v107
    v_and_b32 v135, s61, v107
    s_waitcnt lgkmcnt(3)
    v_lshlrev_b32 v136, 16, v108
    v_and_b32 v137, s61, v108
    v_lshlrev_b32 v138, 16, v109
    v_and_b32 v139, s61, v109
    s_waitcnt lgkmcnt(1)
    v_lshlrev_b32 v140, 16, v110
    v_and_b32 v141, s61, v110
    v_lshlrev_b32 v142, 16, v111
    v_and_b32 v143, s61, v111
    v_lshlrev_b32 v12, 16, v4
    v_and_b32 v13, s61, v4
    v_lshlrev_b32 v14, 16, v5
    v_and_b32 v15, s61, v5
    v_lshlrev_b32 v16, 16, v6
    v_and_b32 v17, s61, v6
    v_lshlrev_b32 v18, 16, v7
    v_and_b32 v19, s61, v7
    v_lshlrev_b32 v20, 16, v8
    v_and_b32 v21, s61, v8
    v_lshlrev_b32 v22, 16, v9
    v_and_b32 v23, s61, v9
    s_waitcnt lgkmcnt(0)
    v_lshlrev_b32 v24, 16, v10
    v_and_b32 v25, s61, v10
    v_lshlrev_b32 v26, 16, v11
    v_and_b32_e64 v27, s61, v11
    s_waitcnt vmcnt(4)
    s_barrier
    buffer_load_dwordx2 v[36:37], v49, s[8:11], 0 offen sc1
    ds_read_b64_tr_b16 v[144:145], v40 offset:0
    s_add_u32 s7, s50, 24576
    ds_read_b64_tr_b16 v[146:147], v40 offset:2048
    ds_read_b64_tr_b16 v[148:149], v41 offset:0
    ds_read_b64_tr_b16 v[150:151], v41 offset:2048
    ds_read_b64_tr_b16 v[152:153], v42 offset:0
    ds_read_b64_tr_b16 v[154:155], v42 offset:2048
    ds_read_b64_tr_b16 v[156:157], v43 offset:0
    buffer_load_dwordx4 v[72:75], v1, s[8:11], s7 offen offset:0 sc1
    ds_read_b64_tr_b16 v[158:159], v43 offset:2048
    ds_read_b64_tr_b16 v[160:161], v40 offset:4096
    ds_read_b64_tr_b16 v[162:163], v40 offset:6144
    ds_read_b64_tr_b16 v[164:165], v41 offset:4096
    ds_read_b64_tr_b16 v[166:167], v41 offset:6144
    ds_read_b64_tr_b16 v[168:169], v42 offset:4096
    ds_read_b64_tr_b16 v[170:171], v42 offset:6144
    buffer_load_dwordx4 v[76:79], v1, s[8:11], s7 offen offset:1024 sc1
    ds_read_b64_tr_b16 v[172:173], v43 offset:4096
    ds_read_b64_tr_b16 v[174:175], v43 offset:6144
    ds_read_b64_tr_b16 v[176:177], v40 offset:14336
    ds_read_b64_tr_b16 v[178:179], v40 offset:16384
    ds_read_b64_tr_b16 v[180:181], v41 offset:14336
    ds_read_b64_tr_b16 v[182:183], v41 offset:16384
    ds_read_b64_tr_b16 v[184:185], v42 offset:14336
    s_add_u32 s7, s50, 28672
    ds_read_b64_tr_b16 v[186:187], v42 offset:16384
    ds_read_b64_tr_b16 v[188:189], v43 offset:14336
    ds_read_b64_tr_b16 v[190:191], v43 offset:16384
    ds_read_b64_tr_b16 v[192:193], v40 offset:18432
    ds_read_b64_tr_b16 v[194:195], v40 offset:20480
    ds_read_b64_tr_b16 v[196:197], v41 offset:18432
    buffer_load_dwordx4 v[80:83], v1, s[8:11], s7 offen offset:0 sc1
    ds_read_b64_tr_b16 v[198:199], v41 offset:20480
    ds_read_b64_tr_b16 v[200:201], v42 offset:18432
    ds_read_b64_tr_b16 v[202:203], v42 offset:20480
    ds_read_b64_tr_b16 v[204:205], v43 offset:18432
    ds_read_b64_tr_b16 v[206:207], v43 offset:20480
    ds_read_b64_tr_b16 v[208:209], v40 offset:28672
    ds_read_b64_tr_b16 v[210:211], v40 offset:30720
    buffer_load_dwordx4 v[84:87], v1, s[8:11], s7 offen offset:1024 sc1
    ds_read_b64_tr_b16 v[212:213], v41 offset:28672
    ds_read_b64_tr_b16 v[214:215], v41 offset:30720
    ds_read_b64_tr_b16 v[216:217], v42 offset:28672
    ds_read_b64_tr_b16 v[218:219], v42 offset:30720
    ds_read_b64_tr_b16 v[220:221], v43 offset:28672
    ds_read_b64_tr_b16 v[222:223], v43 offset:30720
    s_waitcnt lgkmcnt(15)
    s_waitcnt vmcnt(8)
    v_mfma_f32_16x16x32_bf16 v[112:115], v[144:147], v[56:59], 0
    ds_read_b64_tr_b16 v[224:225], v40 offset:32768
    ds_read_b64_tr_b16 v[226:227], v40 offset:34816
    v_mfma_f32_16x16x32_bf16 v[116:119], v[148:151], v[56:59], 0
    ds_read_b64_tr_b16 v[228:229], v41 offset:32768
    ds_read_b64_tr_b16 v[230:231], v41 offset:34816
    v_mfma_f32_16x16x32_bf16 v[120:123], v[152:155], v[56:59], 0
    ds_read_b64_tr_b16 v[232:233], v42 offset:32768
    ds_read_b64_tr_b16 v[234:235], v42 offset:34816
    v_mfma_f32_16x16x32_bf16 v[124:127], v[156:159], v[56:59], 0
    ds_read_b64_tr_b16 v[236:237], v43 offset:32768
    ds_read_b64_tr_b16 v[238:239], v43 offset:34816
    s_waitcnt vmcnt(7)
    v_mfma_f32_16x16x32_bf16 v[112:115], v[160:163], v[60:63], v[112:115]
    ds_read_b64_tr_b16 v[144:145], v40 offset:43008
    ds_read_b64_tr_b16 v[146:147], v40 offset:45056
    v_mfma_f32_16x16x32_bf16 v[116:119], v[164:167], v[60:63], v[116:119]
    ds_read_b64_tr_b16 v[148:149], v41 offset:43008
    ds_read_b64_tr_b16 v[150:151], v41 offset:45056
    v_mfma_f32_16x16x32_bf16 v[120:123], v[168:171], v[60:63], v[120:123]
    ds_read_b64_tr_b16 v[152:153], v42 offset:43008
    ds_read_b64_tr_b16 v[154:155], v42 offset:45056
    v_mfma_f32_16x16x32_bf16 v[124:127], v[172:175], v[60:63], v[124:127]
    ds_read_b64_tr_b16 v[156:157], v43 offset:43008
    ds_read_b64_tr_b16 v[158:159], v43 offset:45056
    s_mov_b32 s40, 0
recurrent_scan__ssm_conv_s4d__mixer_gmlp__prompt_kernel_s4mH_chk:
    s_waitcnt vmcnt(4)
    v_cmp_ne_u64 vcc, v[36:37], v[2:3]
    s_nop 1
    s_cbranch_vccnz recurrent_scan__ssm_conv_s4d__mixer_gmlp__prompt_kernel_s4mH_retry
recurrent_scan__ssm_conv_s4d__mixer_gmlp__prompt_kernel_s4mH_ok:
    s_add_u32 s7, s50, 16384
    v_mfma_f32_16x16x32_bf16 v[112:115], v[176:179], v[64:67], v[112:115]
    ds_read_b64_tr_b16 v[160:161], v40 offset:47104
    ds_read_b64_tr_b16 v[162:163], v40 offset:49152
    v_mfma_f32_16x16x32_bf16 v[116:119], v[180:183], v[64:67], v[116:119]
    buffer_load_dwordx4 v[88:91], v1, s[8:11], s7 offen offset:2048 sc1
    ds_read_b64_tr_b16 v[164:165], v41 offset:47104
    ds_read_b64_tr_b16 v[166:167], v41 offset:49152
    v_mfma_f32_16x16x32_bf16 v[120:123], v[184:187], v[64:67], v[120:123]
    ds_read_b64_tr_b16 v[168:169], v42 offset:47104
    s_add_u32 s7, s50, 20480
    ds_read_b64_tr_b16 v[170:171], v42 offset:49152
    v_mfma_f32_16x16x32_bf16 v[124:127], v[188:191], v[64:67], v[124:127]
    ds_read_b64_tr_b16 v[172:173], v43 offset:47104
    ds_read_b64_tr_b16 v[174:175], v43 offset:49152
    buffer_load_dwordx4 v[92:95], v1, s[8:11], s7 offen offset:2048 sc1
    s_waitcnt lgkmcnt(15)
    v_mfma_f32_16x16x32_bf16 v[112:115], v[192:195], v[68:71], v[112:115]
    ds_read_b64_tr_b16 v[176:177], v40 offset:8192
    ds_read_b64_tr_b16 v[178:179], v40 offset:10240
    s_add_u32 s7, s50, 24576
    v_mfma_f32_16x16x32_bf16 v[116:119], v[196:199], v[68:71], v[116:119]
    ds_read_b64_tr_b16 v[180:181], v41 offset:8192
    ds_read_b64_tr_b16 v[182:183], v41 offset:10240
    v_mfma_f32_16x16x32_bf16 v[120:123], v[200:203], v[68:71], v[120:123]
    buffer_load_dwordx4 v[96:99], v1, s[8:11], s7 offen offset:2048 sc1
    ds_read_b64_tr_b16 v[184:185], v42 offset:8192
    ds_read_b64_tr_b16 v[186:187], v42 offset:10240
    v_mfma_f32_16x16x32_bf16 v[124:127], v[204:207], v[68:71], v[124:127]
    ds_read_b64_tr_b16 v[188:189], v43 offset:8192
    s_add_u32 s7, s50, 28672
    ds_read_b64_tr_b16 v[190:191], v43 offset:10240
    s_waitcnt vmcnt(6)
    v_mfma_f32_16x16x32_bf16 v[112:115], v[208:211], v[72:75], v[112:115]
    ds_read_b64_tr_b16 v[192:193], v40 offset:22528
    buffer_load_dwordx4 v[100:103], v1, s[8:11], s7 offen offset:2048 sc1
    ds_read_b64_tr_b16 v[194:195], v40 offset:24576
    v_mfma_f32_16x16x32_bf16 v[116:119], v[212:215], v[72:75], v[116:119]
    ds_read_b64_tr_b16 v[196:197], v41 offset:22528
    ds_read_b64_tr_b16 v[198:199], v41 offset:24576
    s_add_u32 s7, s50, 16384
    v_mfma_f32_16x16x32_bf16 v[120:123], v[216:219], v[72:75], v[120:123]
    ds_read_b64_tr_b16 v[200:201], v42 offset:22528
    ds_read_b64_tr_b16 v[202:203], v42 offset:24576
    v_mfma_f32_16x16x32_bf16 v[124:127], v[220:223], v[72:75], v[124:127]
    buffer_load_dwordx4 v[240:243], v1, s[8:11], s7 offen offset:3072 sc1
    ds_read_b64_tr_b16 v[204:205], v43 offset:22528
    ds_read_b64_tr_b16 v[206:207], v43 offset:24576
    s_waitcnt vmcnt(7)
    v_mfma_f32_16x16x32_bf16 v[112:115], v[224:227], v[76:79], v[112:115]
    s_add_u32 s7, s50, 20480
    ds_read_b64_tr_b16 v[208:209], v40 offset:36864
    ds_read_b64_tr_b16 v[210:211], v40 offset:38912
    v_mfma_f32_16x16x32_bf16 v[116:119], v[228:231], v[76:79], v[116:119]
    ds_read_b64_tr_b16 v[212:213], v41 offset:36864
    buffer_load_dwordx4 v[244:247], v1, s[8:11], s7 offen offset:3072 sc1
    ds_read_b64_tr_b16 v[214:215], v41 offset:38912
    v_mfma_f32_16x16x32_bf16 v[120:123], v[232:235], v[76:79], v[120:123]
    ds_read_b64_tr_b16 v[216:217], v42 offset:36864
    ds_read_b64_tr_b16 v[218:219], v42 offset:38912
    s_add_u32 s7, s50, 24576
    v_mfma_f32_16x16x32_bf16 v[124:127], v[236:239], v[76:79], v[124:127]
    ds_read_b64_tr_b16 v[220:221], v43 offset:36864
    ds_read_b64_tr_b16 v[222:223], v43 offset:38912
    s_waitcnt lgkmcnt(15)
    buffer_load_dwordx4 v[248:251], v1, s[8:11], s7 offen offset:3072 sc1
    s_waitcnt vmcnt(8)
    v_mfma_f32_16x16x32_bf16 v[112:115], v[144:147], v[80:83], v[112:115]
    ds_read_b64_tr_b16 v[224:225], v40 offset:51200
    ds_read_b64_tr_b16 v[226:227], v40 offset:53248
    v_mfma_f32_16x16x32_bf16 v[116:119], v[148:151], v[80:83], v[116:119]
    s_add_u32 s7, s50, 28672
    ds_read_b64_tr_b16 v[228:229], v41 offset:51200
    ds_read_b64_tr_b16 v[230:231], v41 offset:53248
    v_mfma_f32_16x16x32_bf16 v[120:123], v[152:155], v[80:83], v[120:123]
    ds_read_b64_tr_b16 v[232:233], v42 offset:51200
    buffer_load_dwordx4 v[252:255], v1, s[8:11], s7 offen offset:3072 sc1
    ds_read_b64_tr_b16 v[234:235], v42 offset:53248
    v_mfma_f32_16x16x32_bf16 v[124:127], v[156:159], v[80:83], v[124:127]
    ds_read_b64_tr_b16 v[236:237], v43 offset:51200
    ds_read_b64_tr_b16 v[238:239], v43 offset:53248
    s_waitcnt vmcnt(8)
    v_mfma_f32_16x16x32_bf16 v[112:115], v[160:163], v[84:87], v[112:115]
    ds_read_b64_tr_b16 v[144:145], v40 offset:12288
    ds_read_b64_tr_b16 v[146:147], v40 offset:26624
    v_mfma_f32_16x16x32_bf16 v[116:119], v[164:167], v[84:87], v[116:119]
    ds_read_b64_tr_b16 v[148:149], v41 offset:12288
    ds_read_b64_tr_b16 v[150:151], v41 offset:26624
    v_mfma_f32_16x16x32_bf16 v[120:123], v[168:171], v[84:87], v[120:123]
    ds_read_b64_tr_b16 v[152:153], v42 offset:12288
    ds_read_b64_tr_b16 v[154:155], v42 offset:26624
    v_mfma_f32_16x16x32_bf16 v[124:127], v[172:175], v[84:87], v[124:127]
    ds_read_b64_tr_b16 v[156:157], v43 offset:12288
    ds_read_b64_tr_b16 v[158:159], v43 offset:26624
    s_waitcnt vmcnt(7)
    v_mfma_f32_16x16x32_bf16 v[112:115], v[176:179], v[88:91], v[112:115]
    ds_read_b64_tr_b16 v[160:161], v40 offset:40960
    ds_read_b64_tr_b16 v[162:163], v40 offset:55296
    v_mfma_f32_16x16x32_bf16 v[116:119], v[180:183], v[88:91], v[116:119]
    ds_read_b64_tr_b16 v[164:165], v41 offset:40960
    ds_read_b64_tr_b16 v[166:167], v41 offset:55296
    v_mfma_f32_16x16x32_bf16 v[120:123], v[184:187], v[88:91], v[120:123]
    ds_read_b64_tr_b16 v[168:169], v42 offset:40960
    ds_read_b64_tr_b16 v[170:171], v42 offset:55296
    v_mfma_f32_16x16x32_bf16 v[124:127], v[188:191], v[88:91], v[124:127]
    ds_read_b64_tr_b16 v[172:173], v43 offset:40960
    ds_read_b64_tr_b16 v[174:175], v43 offset:55296
    s_waitcnt lgkmcnt(15)
    s_waitcnt vmcnt(6)
    v_mfma_f32_16x16x32_bf16 v[112:115], v[192:195], v[92:95], v[112:115]
    v_mfma_f32_16x16x32_bf16 v[116:119], v[196:199], v[92:95], v[116:119]
    v_mfma_f32_16x16x32_bf16 v[120:123], v[200:203], v[92:95], v[120:123]
    v_mfma_f32_16x16x32_bf16 v[124:127], v[204:207], v[92:95], v[124:127]
    s_waitcnt vmcnt(5)
    v_mfma_f32_16x16x32_bf16 v[112:115], v[208:211], v[96:99], v[112:115]
    v_mfma_f32_16x16x32_bf16 v[116:119], v[212:215], v[96:99], v[116:119]
    v_mfma_f32_16x16x32_bf16 v[120:123], v[216:219], v[96:99], v[120:123]
    v_mfma_f32_16x16x32_bf16 v[124:127], v[220:223], v[96:99], v[124:127]
    s_waitcnt vmcnt(4)
    v_mfma_f32_16x16x32_bf16 v[112:115], v[224:227], v[100:103], v[112:115]
    v_mfma_f32_16x16x32_bf16 v[116:119], v[228:231], v[100:103], v[116:119]
    v_mfma_f32_16x16x32_bf16 v[120:123], v[232:235], v[100:103], v[120:123]
    v_mfma_f32_16x16x32_bf16 v[124:127], v[236:239], v[100:103], v[124:127]
    s_mov_b32 s40, 0
recurrent_scan__ssm_conv_s4d__mixer_gmlp__prompt_kernel_s4bH_chk:
    s_waitcnt vmcnt(0)
    v_xor_b32 v110, v253, v2
    v_xor_b32 v111, v255, v3
    v_xor_b32 v108, v249, v2
    v_xor_b32 v109, v251, v3
    v_xor_b32 v106, v245, v2
    v_xor_b32 v107, v247, v3
    v_xor_b32 v104, v241, v2
    v_xor_b32 v105, v243, v3
    v_or3_b32 v104, v104, v105, v106
    v_or3_b32 v107, v107, v108, v109
    v_or3_b32 v104, v104, v110, v111
    v_or_b32 v104, v104, v107
    v_cmp_ne_u32 vcc, 0, v104
    s_nop 1
    s_cbranch_vccnz recurrent_scan__ssm_conv_s4d__mixer_gmlp__prompt_kernel_s4bH_retry
recurrent_scan__ssm_conv_s4d__mixer_gmlp__prompt_kernel_s4bH_ok:
    v_mov_b32 v241, v242
    v_mov_b32 v242, v244
    v_mov_b32 v243, v246
    v_mov_b32 v249, v250
    v_mov_b32 v250, v252
    v_mov_b32 v251, v254
    s_barrier
    ds_read_b128 v[56:59], v50 offset:0
    ds_read_b128 v[60:63], v50 offset:1024
    ds_read_b128 v[64:67], v50 offset:2048
    ds_read_b128 v[68:71], v50 offset:3072
    s_waitcnt lgkmcnt(15)
    v_mfma_f32_16x16x32_bf16 v[112:115], v[144:147], v[240:243], v[112:115]
    v_mfma_f32_16x16x32_bf16 v[116:119], v[148:151], v[240:243], v[116:119]
    s_waitcnt lgkmcnt(14)
    v_mfma_f32_16x16x32_bf16 v[120:123], v[152:155], v[240:243], v[120:123]
    s_waitcnt lgkmcnt(12)
    v_mfma_f32_16x16x32_bf16 v[124:127], v[156:159], v[240:243], v[124:127]
    s_waitcnt lgkmcnt(10)
    v_mfma_f32_16x16x32_bf16 v[112:115], v[160:163], v[248:251], v[112:115]
    s_waitcnt lgkmcnt(8)
    v_mfma_f32_16x16x32_bf16 v[116:119], v[164:167], v[248:251], v[116:119]
    s_waitcnt lgkmcnt(6)
    v_mfma_f32_16x16x32_bf16 v[120:123], v[168:171], v[248:251], v[120:123]
    s_waitcnt lgkmcnt(4)
    v_mfma_f32_16x16x32_bf16 v[124:127], v[172:175], v[248:251], v[124:127]
    s_mov_b32 s38, 0xbfb8aa3b
    s_waitcnt lgkmcnt(3)
    v_pk_add_f32 v[112:113], v[112:113], v[56:57]
    v_pk_add_f32 v[114:115], v[114:115], v[58:59]
    s_waitcnt lgkmcnt(2)
    v_pk_add_f32 v[116:117], v[116:117], v[60:61]
    v_pk_add_f32 v[118:119], v[118:119], v[62:63]
    v_pk_mul_f32 v[72:73], v[112:113], s[38:39] op_sel_hi:[1,0]
    v_pk_mul_f32 v[74:75], v[114:115], s[38:39] op_sel_hi:[1,0]
    v_pk_mul_f32 v[76:77], v[116:117], s[38:39] op_sel_hi:[1,0]
    v_pk_mul_f32 v[78:79], v[118:119], s[38:39] op_sel_hi:[1,0]
    v_exp_f32 v72, v72
    v_exp_f32 v73, v73
    v_exp_f32 v74, v74
    v_exp_f32 v75, v75
    v_exp_f32 v76, v76
    v_exp_f32 v77, v77
    v_exp_f32 v78, v78
    v_exp_f32_e64 v79, v79
    v_pk_add_f32 v[72:73], v[72:73], 1.0 op_sel_hi:[1,0]
    v_pk_mul_f32 v[112:113], v[112:113], v[12:13]
    v_pk_add_f32 v[74:75], v[74:75], 1.0 op_sel_hi:[1,0]
    v_pk_mul_f32 v[114:115], v[114:115], v[14:15]
    v_pk_add_f32 v[76:77], v[76:77], 1.0 op_sel_hi:[1,0]
    v_pk_mul_f32 v[116:117], v[116:117], v[16:17]
    v_pk_add_f32 v[78:79], v[78:79], 1.0 op_sel_hi:[1,0]
    v_pk_mul_f32 v[118:119], v[118:119], v[18:19]
    v_rcp_f32 v72, v72
    v_rcp_f32 v73, v73
    v_rcp_f32 v74, v74
    v_rcp_f32 v75, v75
    v_pk_fma_f32 v[72:73], v[72:73], v[112:113], v[128:129]
    v_pk_fma_f32 v[74:75], v[74:75], v[114:115], v[130:131]
    v_cvt_pk_bf16_f32 v104, v72, v73
    v_cvt_pk_bf16_f32 v105, v74, v75
    ds_write_b64 v44, v[104:105]
    v_rcp_f32 v76, v76
    v_rcp_f32 v77, v77
    v_rcp_f32 v78, v78
    v_rcp_f32 v79, v79
    v_pk_fma_f32 v[76:77], v[76:77], v[116:117], v[132:133]
    v_pk_fma_f32 v[78:79], v[78:79], v[118:119], v[134:135]
    v_cvt_pk_bf16_f32 v106, v76, v77
    v_cvt_pk_bf16_f32 v107, v78, v79
    ds_write_b64 v45, v[106:107]
    s_waitcnt lgkmcnt(3)
    v_pk_add_f32 v[120:121], v[120:121], v[64:65]
    v_pk_add_f32 v[122:123], v[122:123], v[66:67]
    s_waitcnt lgkmcnt(2)
    v_pk_add_f32 v[124:125], v[124:125], v[68:69]
    v_pk_add_f32 v[126:127], v[126:127], v[70:71]
    v_pk_mul_f32 v[80:81], v[120:121], s[38:39] op_sel_hi:[1,0]
    v_pk_mul_f32 v[82:83], v[122:123], s[38:39] op_sel_hi:[1,0]
    v_pk_mul_f32 v[84:85], v[124:125], s[38:39] op_sel_hi:[1,0]
    v_pk_mul_f32 v[86:87], v[126:127], s[38:39] op_sel_hi:[1,0]
    v_exp_f32 v80, v80
    v_exp_f32 v81, v81
    v_exp_f32 v82, v82
    v_exp_f32 v83, v83
    v_exp_f32 v84, v84
    v_exp_f32 v85, v85
    v_exp_f32 v86, v86
    v_exp_f32 v87, v87
    v_pk_add_f32 v[80:81], v[80:81], 1.0 op_sel_hi:[1,0]
    v_pk_mul_f32 v[120:121], v[120:121], v[20:21]
    v_pk_add_f32 v[82:83], v[82:83], 1.0 op_sel_hi:[1,0]
    v_pk_mul_f32 v[122:123], v[122:123], v[22:23]
    v_pk_add_f32 v[84:85], v[84:85], 1.0 op_sel_hi:[1,0]
    v_pk_mul_f32 v[124:125], v[124:125], v[24:25]
    v_pk_add_f32 v[86:87], v[86:87], 1.0 op_sel_hi:[1,0]
    v_pk_mul_f32 v[126:127], v[126:127], v[26:27]
    v_rcp_f32 v80, v80
    v_rcp_f32 v81, v81
    v_rcp_f32 v82, v82
    v_rcp_f32 v83, v83
    v_pk_fma_f32 v[80:81], v[80:81], v[120:121], v[136:137]
    v_pk_fma_f32 v[82:83], v[82:83], v[122:123], v[138:139]
    v_cvt_pk_bf16_f32 v108, v80, v81
    v_cvt_pk_bf16_f32 v109, v82, v83
    ds_write_b64 v46, v[108:109]
    v_rcp_f32 v84, v84
    v_rcp_f32 v85, v85
    v_rcp_f32 v86, v86
    v_rcp_f32 v87, v87
    v_pk_fma_f32 v[84:85], v[84:85], v[124:125], v[140:141]
    v_pk_fma_f32 v[86:87], v[86:87], v[126:127], v[142:143]
    v_cvt_pk_bf16_f32 v110, v84, v85
    v_cvt_pk_bf16_f32 v111, v86, v87
    ds_write_b64 v47, v[110:111]
    ds_read_b128 v[4:7], v51 offset:0
    ds_read_b128 v[8:11], v51 offset:1024
    s_waitcnt lgkmcnt(1)
    buffer_store_dwordx4 v[4:7], v52, s[28:31], s54 offen offset:0 sc1
    s_waitcnt lgkmcnt(0)
    buffer_store_dwordx4 v[8:11], v53, s[28:31], s54 offen offset:1024 sc1
    s_endpgm
recurrent_scan__ssm_conv_s4d__mixer_gmlp__prompt_kernel_s1_retry:
    s_add_u32 s40, s40, 1
    s_cmp_ge_u32 s40, 40000
    s_cbranch_scc1 recurrent_scan__ssm_conv_s4d__mixer_gmlp__prompt_kernel_s1_ok
    s_sleep 4
    buffer_load_dwordx4 v[40:43], v20, s[8:11], s36 offen offset:0 sc1
    buffer_load_dwordx4 v[44:47], v20, s[8:11], s36 offen offset:256 sc1
    s_waitcnt vmcnt(0)
    s_branch recurrent_scan__ssm_conv_s4d__mixer_gmlp__prompt_kernel_s1_chk
recurrent_scan__ssm_conv_s4d__mixer_gmlp__prompt_kernel_s2G_retry:
    s_add_u32 s40, s40, 1
    s_cmp_ge_u32 s40, 40000
    s_cbranch_scc1 recurrent_scan__ssm_conv_s4d__mixer_gmlp__prompt_kernel_s2G_ok
    s_sleep 4
    buffer_load_dwordx2 v[36:37], v35, s[8:11], s41 offen sc1
    s_waitcnt vmcnt(0)
    s_branch recurrent_scan__ssm_conv_s4d__mixer_gmlp__prompt_kernel_s2G_chk
recurrent_scan__ssm_conv_s4d__mixer_gmlp__prompt_kernel_s4aG_retry:
    s_add_u32 s40, s40, 1
    s_cmp_ge_u32 s40, 40000
    s_cbranch_scc1 recurrent_scan__ssm_conv_s4d__mixer_gmlp__prompt_kernel_s4aG_ok
    s_sleep 4
    buffer_load_dwordx2 v[36:37], v35, s[8:11], s41 offen sc1
    s_waitcnt vmcnt(0)
    s_branch recurrent_scan__ssm_conv_s4d__mixer_gmlp__prompt_kernel_s4aG_chk
recurrent_scan__ssm_conv_s4d__mixer_gmlp__prompt_kernel_s4mG_retry:
    s_add_u32 s40, s40, 1
    s_cmp_ge_u32 s40, 40000
    s_cbranch_scc1 recurrent_scan__ssm_conv_s4d__mixer_gmlp__prompt_kernel_s4mG_ok
    s_sleep 4
    buffer_load_dwordx2 v[36:37], v137, s[8:11], 0 offen sc1
    s_waitcnt vmcnt(0)
    s_branch recurrent_scan__ssm_conv_s4d__mixer_gmlp__prompt_kernel_s4mG_chk
recurrent_scan__ssm_conv_s4d__mixer_gmlp__prompt_kernel_s4bG_retry:
    s_add_u32 s40, s40, 1
    s_cmp_ge_u32 s40, 40000
    s_cbranch_scc1 recurrent_scan__ssm_conv_s4d__mixer_gmlp__prompt_kernel_s4bG_ok
    s_sleep 4
    s_add_u32 s7, s50, 0
    buffer_load_dwordx4 v[240:243], v1, s[8:11], s7 offen offset:3072 sc1
    s_add_u32 s7, s50, 4096
    buffer_load_dwordx4 v[244:247], v1, s[8:11], s7 offen offset:3072 sc1
    s_add_u32 s7, s50, 8192
    buffer_load_dwordx4 v[248:251], v1, s[8:11], s7 offen offset:3072 sc1
    s_add_u32 s7, s50, 12288
    buffer_load_dwordx4 v[252:255], v1, s[8:11], s7 offen offset:3072 sc1
    s_waitcnt vmcnt(0)
    s_branch recurrent_scan__ssm_conv_s4d__mixer_gmlp__prompt_kernel_s4bG_chk
recurrent_scan__ssm_conv_s4d__mixer_gmlp__prompt_kernel_sx_retry:
    s_add_u32 s40, s40, 1
    s_cmp_ge_u32 s40, 40000
    s_cbranch_scc1 recurrent_scan__ssm_conv_s4d__mixer_gmlp__prompt_kernel_sx_ok
    s_sleep 4
    buffer_load_dwordx2 v[36:37], v35, s[8:11], s41 offen sc1
    s_waitcnt vmcnt(0)
    s_branch recurrent_scan__ssm_conv_s4d__mixer_gmlp__prompt_kernel_sx_chk
recurrent_scan__ssm_conv_s4d__mixer_gmlp__prompt_kernel_s5_retry:
    s_add_u32 s40, s40, 1
    s_cmp_ge_u32 s40, 40000
    s_cbranch_scc1 recurrent_scan__ssm_conv_s4d__mixer_gmlp__prompt_kernel_s5_ok
    s_sleep 4
    buffer_load_dwordx2 v[36:37], v35, s[8:11], s41 offen sc1
    s_waitcnt vmcnt(0)
    s_branch recurrent_scan__ssm_conv_s4d__mixer_gmlp__prompt_kernel_s5_chk
recurrent_scan__ssm_conv_s4d__mixer_gmlp__prompt_kernel_s4aH_retry:
    s_add_u32 s40, s40, 1
    s_cmp_ge_u32 s40, 40000
    s_cbranch_scc1 recurrent_scan__ssm_conv_s4d__mixer_gmlp__prompt_kernel_s4aH_ok
    s_sleep 4
    buffer_load_dwordx2 v[36:37], v35, s[8:11], s41 offen sc1
    s_waitcnt vmcnt(0)
    s_branch recurrent_scan__ssm_conv_s4d__mixer_gmlp__prompt_kernel_s4aH_chk
recurrent_scan__ssm_conv_s4d__mixer_gmlp__prompt_kernel_s4mH_retry:
    s_add_u32 s40, s40, 1
    s_cmp_ge_u32 s40, 40000
    s_cbranch_scc1 recurrent_scan__ssm_conv_s4d__mixer_gmlp__prompt_kernel_s4mH_ok
    s_sleep 4
    buffer_load_dwordx2 v[36:37], v49, s[8:11], 0 offen sc1
    s_waitcnt vmcnt(0)
    s_branch recurrent_scan__ssm_conv_s4d__mixer_gmlp__prompt_kernel_s4mH_chk
recurrent_scan__ssm_conv_s4d__mixer_gmlp__prompt_kernel_s4bH_retry:
    s_add_u32 s40, s40, 1
    s_cmp_ge_u32 s40, 40000
    s_cbranch_scc1 recurrent_scan__ssm_conv_s4d__mixer_gmlp__prompt_kernel_s4bH_ok
    s_sleep 4
    s_add_u32 s7, s50, 16384
    buffer_load_dwordx4 v[240:243], v1, s[8:11], s7 offen offset:3072 sc1
    s_add_u32 s7, s50, 20480
    buffer_load_dwordx4 v[244:247], v1, s[8:11], s7 offen offset:3072 sc1
    s_add_u32 s7, s50, 24576
    buffer_load_dwordx4 v[248:251], v1, s[8:11], s7 offen offset:3072 sc1
    s_add_u32 s7, s50, 28672
    buffer_load_dwordx4 v[252:255], v1, s[8:11], s7 offen offset:3072 sc1
    s_waitcnt vmcnt(0)
    s_branch recurrent_scan__ssm_conv_s4d__mixer_gmlp__prompt_kernel_s4bH_chk
recurrent_scan__ssm_conv_s4d__mixer_gmlp__prompt_kernel_end:
    s_endpgm
code_end:
    s_endpgm
.section .rodata,"a"
.p2align 6
.amdhsa_kernel recurrent_scan__ssm_conv_s4d__mixer_gmlp__prompt_kernel
  .amdhsa_next_free_vgpr 256
  .amdhsa_next_free_sgpr 100
  .amdhsa_accum_offset 256
  .amdhsa_group_segment_fixed_size 0
  .amdhsa_kernarg_size 120
  .amdhsa_user_sgpr_count 2
  .amdhsa_user_sgpr_kernarg_segment_ptr 1
  .amdhsa_system_sgpr_workgroup_id_x 1
.end_amdhsa_kernel
```
